```python
import torch

def _softmax(x, axis=-1):
    return torch.softmax(x, dim=axis)
def _gelu(x):
    return torch.nn.functional.gelu(x, approximate="tanh")
def _silu(x):
    return torch.nn.functional.silu(x)
def _sigmoid(x):
    return torch.sigmoid(x)
def _layernorm(x, axis=-1, eps=1e-5):
    m = x.mean(dim=axis, keepdim=True)
    v = x.var(dim=axis, keepdim=True, unbiased=False)
    return (x - m) / torch.sqrt(v + eps)
def _scatter_add(tgt, idx, src, axis=0):
    return tgt.clone().index_add_(axis, idx, src)
def _segment_sum(src, seg, n):
    out = torch.zeros((n,) + src.shape[1:], dtype=src.dtype)
    return out.index_add_(0, seg, src)
def _pad(x, pw):
    flat = tuple(v for pair in reversed(pw) for v in pair)
    return torch.nn.functional.pad(x, flat)

kernel_name = 'standalone__deep_cross_fibinet__recsys'

def setup_inputs():

    _w = (lambda a: (lambda t: t.to(torch.bfloat16) if t.is_floating_point() else t)(torch.as_tensor(a)))
    B, F, D = 4096, 26, 64
    V = min(1000, 100000)
    Fr = max(F // 2, 1)
    H = min(F * D, 256)
    return {
        "idx": _w((lambda lo, hi, *s: torch.randint(lo, hi, s))(0, V, B, F).to(torch.int64)),
        "table": _w((lambda *s: torch.randn(*s, dtype=torch.bfloat16) * 1.6)(V, D)),
        "se_w1": _w((lambda *s: torch.randn(*s, dtype=torch.bfloat16) * 1.6)(F, Fr)),
        "se_w2": _w((lambda *s: torch.randn(*s, dtype=torch.bfloat16) * 1.6)(Fr, F)),
        "w_bi": _w((lambda *s: torch.randn(*s, dtype=torch.bfloat16) * 0.05)(D, D) * (D ** -0.5)),
        "w_cross": _w((lambda *s: torch.randn(*s, dtype=torch.bfloat16) * 0.05)(2 * F * F * D) * 0.01),
        "w_deep1": _w((lambda *s: torch.randn(*s, dtype=torch.bfloat16) * 0.8)(F * D, H) * ((F * D) ** -0.5)),
        "w_deep2": _w((lambda *s: torch.randn(*s, dtype=torch.bfloat16) * 0.05)(H) * 0.01),
    }

def reference(idx, table, se_w1, se_w2, w_bi, w_cross, w_deep1, w_deep2):
    emb = table[idx]
    B = emb.shape[0]
    z = emb.mean(axis=-1)
    a = _sigmoid(_gelu(z @ se_w1) @ se_w2)
    v = a[:, :, None] * emb
    eW = torch.einsum('bfd,de->bfe', emb, w_bi)
    vW = torch.einsum('bfd,de->bfe', v, w_bi)
    p = torch.einsum('bie,bje->bije', eW, emb).reshape(B, -1)
    q = torch.einsum('bie,bje->bije', vW, v).reshape(B, -1)
    cross_feat = torch.concatenate([p, q], axis=-1)
    logit_cross = cross_feat @ w_cross
    h = _gelu(emb.reshape(B, -1) @ w_deep1)
    logit_deep = h @ w_deep2
    return logit_cross + logit_deep
```

```asm
; @launch grid=(256,1,1) block=(512,1,1) lds=161792
.amdgcn_target "amdgcn-amd-amdhsa--gfx950"
.text
.globl standalone__deep_cross_fibinet__recsys_kernel
.p2align 10
.p2align 8
.type standalone__deep_cross_fibinet__recsys_kernel,@function
standalone__deep_cross_fibinet__recsys_kernel:
s_cmp_ge_u32 s2, 256
s_cbranch_scc1 L_exit
s_load_dwordx16 s[16:31], s[0:1], 0
s_load_dwordx4 s[32:35], s[0:1], 64
s_load_dwordx2 s[36:37], s[0:1], 80
v_lshrrev_b32 v1, 6, v0
v_and_b32 v0, 63, v0
v_readfirstlane_b32 s40, v1
s_and_b32 s41, s2, 3
s_lshr_b32 s42, s2, 2
s_lshr_b32 s38, s2, 3
s_and_b32 s43, s40, 3
s_mov_b32 s3, 0
s_lshl_b32 s39, s43, 12
s_add_u32 s9, s39, 16384
s_add_u32 s39, s39, 63488
v_lshlrev_b32 v1, 4, v0
v_mov_b32 v122, 0
v_lshrrev_b32 v12, 3, v0
v_and_b32 v13, 7, v0
v_bfe_u32 v14, v0, 4, 1
v_lshlrev_b32 v14, 2, v14
v_xor_b32 v2, v13, v14
v_lshlrev_b32 v2, 4, v2
v_lshl_add_u32 v2, v12, 9, v2
s_lshl_b32 s4, s43, 13
s_lshl_b32 s5, s41, 7
s_add_u32 s4, s4, s5
s_add_u32 s4, s4, 4096
v_add_u32 v2, s4, v2
v_add_u32 v3, 3072, v2
s_cmp_lt_u32 s40, 4
s_cbranch_scc1 L_entry
s_mul_i32 s6, s42, 6656
s_mul_i32 s7, s43, 1664
s_add_u32 s6, s6, s7
s_lshl_b32 s7, s43, 11
s_mov_b32 m0, s7
s_waitcnt lgkmcnt(0)
s_mov_b32 s52, s16
s_mov_b32 s53, s17
s_mov_b32 s54, 425984
s_mov_b32 s55, 0x00020000
buffer_load_dwordx4 v1, s[52:55], s6 offen lds
buffer_load_dwordx4 v1, s[52:55], s6 offen offset:1024 lds
s_mov_b32 s56, s30
s_mov_b32 s57, s31
s_mov_b32 s58, 512
s_mov_b32 s59, 0x00020000
s_mov_b32 m0, 62464
v_lshlrev_b32 v14, 2, v0
s_lshl_b32 s4, s41, 7
buffer_load_dword v14, s[56:59], s4 offen lds
s_setprio 2
v_lshrrev_b32 v14, 1, v12
v_xor_b32 v4, v13, v14
v_xor_b32 v5, 4, v4
v_lshlrev_b32 v4, 4, v4
v_lshlrev_b32 v5, 4, v5
v_add_u32 v6, 2048, v4
v_add_u32 v7, 1024, v5
v_add_u32 v4, 4096, v4
v_add_u32 v5, 3072, v5
v_mul_u32_u24 v11, 104, v12
v_add_u32 v11, s7, v11
s_sub_u32 s44, s18, 4096
s_subb_u32 s45, s19, 0
s_mov_b32 s46, 132096
s_mov_b32 s47, 0x00020000
s_mov_b64 exec, 0
s_cmp_eq_u32 s43, 0
s_cbranch_scc1 TCH_e_0
s_cmp_eq_u32 s43, 1
s_cbranch_scc1 TCH_e_1
s_cmp_eq_u32 s43, 2
s_cbranch_scc1 TCH_e_2
s_branch TCH_e_3
RET_e:
s_mov_b64 exec, -1
s_waitcnt vmcnt(1)
ds_read_b64 v[128:129], v11 offset:0
ds_read_b64 v[154:155], v11 offset:832
ds_read_b64 v[130:131], v11 offset:8
ds_read_b64 v[156:157], v11 offset:840
s_waitcnt lgkmcnt(2)
s_add_u32 m0, s39, 0
v_lshl_add_u32 v128, v128, 7, v4
buffer_load_dwordx4 v128, s[44:47], 0 offen lds
v_lshl_add_u32 v154, v154, 7, v5
buffer_load_dwordx4 v154, s[44:47], 0 offen offset:1024 lds
v_lshl_add_u32 v129, v129, 7, v6
buffer_load_dwordx4 v129, s[44:47], 0 offen offset:2048 lds
v_lshl_add_u32 v155, v155, 7, v7
buffer_load_dwordx4 v155, s[44:47], 0 offen offset:3072 lds
s_branch D_entry
L_entry:
s_lshl_b32 s8, s38, 2
s_add_u32 s8, s8, s43
s_lshl_b32 s8, s8, 10
s_lshl_b32 s14, s43, 8
s_or_b32 s14, s14, s2
s_memrealtime s[12:13]
s_waitcnt lgkmcnt(0)
s_mov_b32 s44, s18
s_mov_b32 s45, s19
s_mov_b32 s46, 128000
s_mov_b32 s47, 0x00020000
s_cmp_ge_u32 s14, 125
s_cbranch_scc1 L_nz
s_lshl_b32 s4, s2, 10
buffer_load_dwordx4 v[240:243], v1, s[44:47], s4 offen
s_cmp_lg_u32 s14, 0
s_cbranch_scc1 L_nz
s_or_b32 s12, s12, 1
v_mov_b32 v38, s12
v_mov_b32 v39, s13
s_mov_b64 exec, 1
global_store_dwordx2 v122, v[38:39], s[34:35] sc1
s_mov_b64 exec, -1
L_nz:
s_sub_u32 s48, s28, 4096
s_subb_u32 s49, s29, 0
s_mov_b32 s50, 856064
s_mov_b32 s51, 0x00020000
s_mov_b32 m0, s9
s_nop 0
buffer_load_dwordx4 v1, s[44:47], s8 offen lds
s_add_u32 m0, s39, 16384
s_mov_b32 s10, 0
buffer_load_dwordx4 v2, s[48:51], s10 offen lds
buffer_load_dwordx4 v3, s[48:51], s10 offen offset:1024 lds
s_mov_b32 s10, 30720
buffer_load_dwordx4 v2, s[48:51], s10 offen offset:2048 lds
buffer_load_dwordx4 v3, s[48:51], s10 offen offset:3072 lds
s_cmp_lt_u32 s43, 2
s_cselect_b32 s56, s24, s20
s_cselect_b32 s57, s25, s21
s_movk_i32 s58, 676
s_cselect_b32 s58, 8192, s58
s_cselect_b64 s[6:7], -1, 0
s_cmp_eq_u32 s43, 3
s_cselect_b32 s56, s22, s56
s_cselect_b32 s57, s23, s57
s_mov_b32 s59, 0x00020000
v_lshrrev_b32 v14, 1, v0
v_lshlrev_b32 v14, 7, v14
v_and_b32 v15, 1, v0
v_lshl_add_u32 v14, v15, 4, v14
s_lshl_b32 s4, s41, 5
s_add_u32 s4, s4, s39
s_sub_u32 s4, s4, 63488
v_add_u32 v14, s4, v14
v_cndmask_b32 v6, v1, v14, s[6:7]
s_lshl_b32 s4, s43, 10
s_add_u32 m0, s4, 12288
s_mov_b32 s60, s36
s_mov_b32 s61, s37
s_mov_b32 s62, 458752
s_mov_b32 s63, 0x00020000
buffer_load_dwordx4 v6, s[56:59], 0 offen lds
s_cmp_ge_u32 s38, 24
s_cselect_b32 s4, 24, 0
s_sub_u32 s4, s38, s4
s_add_u32 s4, s4, 2
s_lshl_b32 s10, s4, 15
s_lshl_b32 s9, s43, 12
s_add_u32 m0, s9, 16384
s_nop 0
buffer_load_dwordx4 v2, s[48:51], s10 offen lds
buffer_load_dwordx4 v3, s[48:51], s10 offen offset:1024 lds
v_lshrrev_b32 v116, 4, v0
v_and_b32 v117, 15, v0
s_cmp_eq_u32 s43, 0
s_cbranch_scc1 L_w0
s_mov_b64 exec, 0
s_cmp_eq_u32 s43, 1
s_cbranch_scc1 TCH_f_1
s_cmp_eq_u32 s43, 2
s_cbranch_scc1 TCH_f_2
s_branch TCH_f_3
RET_f:
s_mov_b64 exec, -1
s_branch L_common
L_w0:
s_sub_u32 s15, s14, 128
s_cmp_ge_u32 s15, 104
s_cbranch_scc1 L_common
s_mov_b32 s68, s26
s_mov_b32 s69, s27
s_mov_b32 s70, 173056
s_nop 0
s_mov_b32 s71, 0x00020000
s_cmp_ge_u32 s15, 52
s_cselect_b32 s8, 1, 0
s_cselect_b32 s4, 52, 0
s_sub_u32 s4, s15, s4
s_lshr_b32 s9, s4, 1
s_and_b32 s10, s4, 1
v_lshlrev_b32 v12, 3, v116
v_bfe_u32 v13, v0, 3, 1
v_add_u32 v12, v12, v13
v_add_u32 v15, 24, v13
s_lshl_b32 s4, s10, 2
v_add_u32 v12, s4, v12
s_mul_i32 s4, s8, 676
s_add_u32 s4, s4, s9
s_lshl_b32 s4, s4, 7
v_and_b32 v13, 7, v0
v_lshlrev_b32 v13, 4, v13
s_mov_b32 m0, 32768
v_min_u32 v14, v12, v15
v_mul_u32_u24 v14, 3328, v14
v_add_u32 v14, v14, v13
buffer_load_dwordx4 v14, s[68:71], s4 offen lds
v_add_u32 v12, 2, v12
s_mov_b32 m0, 33792
v_min_u32 v14, v12, v15
v_mul_u32_u24 v14, 3328, v14
v_add_u32 v14, v14, v13
buffer_load_dwordx4 v14, s[68:71], s4 offen lds
s_sub_u32 s68, s9, 16
s_lshl_b32 s4, s10, 5
s_add_u32 s4, s4, 0
s_add_u32 s4, s4, s9
s_lshl_b32 s11, s8, 6
s_add_u32 s4, s4, s11
s_cmp_lt_u32 s68, 6
s_movk_i32 s5, 26
s_cselect_b32 s5, 10, s5
s_cmp_eq_u32 s10, 0
s_cselect_b32 s5, 0, s5
s_add_u32 s5, s5, s68
s_mul_i32 s11, s8, 40
s_add_u32 s5, s5, s11
s_add_u32 s5, s5, 2048
s_cmp_lt_u32 s9, 16
s_cselect_b32 s4, s4, s5
s_lshl_b32 s70, s4, 4
s_lshl_b32 s4, s10, 5
s_add_u32 s4, s4, 16
s_add_u32 s4, s4, s9
s_lshl_b32 s11, s8, 6
s_add_u32 s4, s4, s11
s_cmp_lt_u32 s68, 6
s_movk_i32 s5, 30
s_cselect_b32 s5, 26, s5
s_cmp_eq_u32 s10, 0
s_cselect_b32 s5, 16, s5
s_add_u32 s5, s5, s68
s_mul_i32 s11, s8, 40
s_add_u32 s5, s5, s11
s_add_u32 s5, s5, 2048
s_cmp_lt_u32 s9, 16
s_cselect_b32 s4, s4, s5
s_lshl_b32 s71, s4, 4
s_cmp_lt_u32 s9, 16
s_movk_i32 s68, 1280
s_cselect_b32 s68, 2048, s68
s_lshl_b32 s69, s10, 1
s_lshl_b32 s72, s15, 5
s_add_u32 s72, s72, 266240
L_common:
v_lshrrev_b32 v12, 1, v117
v_xor_b32 v7, v12, v116
v_lshlrev_b32 v7, 4, v7
v_lshl_add_u32 v7, v117, 7, v7
v_add_u32 v7, s39, v7
v_xor_b32 v8, 64, v7
v_add_u32 v9, 0x10000, v7
v_add_u32 v10, 0x10000, v8
s_lshl_b32 s4, s41, 1
v_xor_b32 v11, s4, v12
v_lshlrev_b32 v11, 4, v11
v_lshl_add_u32 v11, v117, 7, v11
v_add_u32 v11, s39, v11
v_and_b32 v12, 1, v116
v_lshl_add_u32 v11, v12, 11, v11
v_xor_b32 v12, 16, v11
v_add_u32 v13, 0x10000, v11
v_add_u32 v14, 0x10000, v12
s_lshl_b32 s7, s43, 11
v_mul_u32_u24 v145, 104, v117
v_lshl_add_u32 v145, v116, 2, v145
v_add_u32 v145, s7, v145
v_bfe_u32 v149, v0, 2, 2
v_and_b32 v153, 3, v0
v_lshl_add_u32 v129, v116, 3, v149
v_lshlrev_b32 v129, 5, v129
v_lshl_add_u32 v129, v153, 3, v129
v_lshlrev_b32 v121, 7, v149
v_lshl_add_u32 v121, v116, 5, v121
v_lshl_add_u32 v121, v153, 3, v121
v_mul_u32_u24 v133, 26, v116
v_lshl_add_u32 v133, v117, 1, v133
v_cmp_lt_u32 vcc, 12, v117
v_mov_b32 v23, 300
v_mov_b32 v24, 700
v_cndmask_b32 v137, v133, v23, vcc
v_cndmask_b32 v133, v133, v24, vcc
v_lshl_add_u32 v153, v153, 2, v149
v_mul_u32_u24 v141, 208, v116
v_lshl_add_u32 v141, v153, 1, v141
v_min_u32 v6, 57, v0
v_lshlrev_b32 v6, 4, v6
s_mov_b32 s73, 0xbdd2d3e8
v_lshl_add_u32 v4, v116, 4, v153
v_lshlrev_b32 v4, 4, v4
v_cmp_lt_u32 vcc, 9, v153
v_and_b32 v25, 1, v116
v_mov_b32 v123, v149
v_cndmask_b32 v153, v153, v149, vcc
v_lshl_add_u32 v5, v25, 4, v153
v_add_u32 v24, 10, v5
v_lshl_add_u32 v25, v25, 2, v153
v_add_u32 v25, 26, v25
v_cmp_lt_u32 vcc, 5, v153
v_cmp_lt_u32 s[4:5], 1, v116
s_lshl_b32 s6, s43, 6
s_add_u32 s6, s6, 61952
v_lshl_add_u32 v2, v117, 2, s6
v_lshlrev_b32 v3, 3, v117
v_cndmask_b32 v24, v24, v25, vcc
v_cndmask_b32 v5, v5, v24, s[4:5]
v_lshlrev_b32 v5, 4, v5
v_add_u32 v5, 0x8000, v5
s_mov_b32 s76, -1
s_mov_b32 s77, 0
s_mov_b32 s74, 0
s_mov_b32 s75, -1
s_cmp_lg_u32 s43, 0
s_cbranch_scc1 L_tch
s_cmp_ge_u32 s2, 125
s_cbranch_scc1 P_noz
s_waitcnt vmcnt(8)
v_lshlrev_b32 v244, 16, v240
v_and_b32 v240, 0xffff0000, v240
v_lshlrev_b32 v245, 16, v241
v_and_b32 v241, 0xffff0000, v241
v_lshlrev_b32 v246, 16, v242
v_and_b32 v242, 0xffff0000, v242
v_lshlrev_b32 v247, 16, v243
v_and_b32 v243, 0xffff0000, v243
v_add_f32 v240, v240, v244
v_add_f32 v241, v241, v245
v_add_f32 v242, v242, v246
v_add_f32 v243, v243, v247
v_add_f32 v240, v240, v241
v_add_f32 v242, v242, v243
v_add_f32 v240, v240, v242
s_memrealtime s[12:13]
s_nop 0
v_add_f32_dpp v240, v240, v240 quad_perm:[1,0,3,2] row_mask:0xf bank_mask:0xf
s_nop 1
v_add_f32_dpp v240, v240, v240 quad_perm:[2,3,0,1] row_mask:0xf bank_mask:0xf
s_nop 1
v_add_f32_dpp v240, v240, v240 row_half_mirror row_mask:0xf bank_mask:0xf
v_mul_f32 v240, 0x3c800000, v240
v_cvt_pk_bf16_f32 v240, v240, v240
s_nop 0
v_readlane_b32 s64, v240, 0
v_readlane_b32 s65, v240, 8
v_readlane_b32 s66, v240, 16
v_readlane_b32 s67, v240, 24
v_readlane_b32 s68, v240, 32
v_readlane_b32 s69, v240, 40
v_readlane_b32 s70, v240, 48
v_readlane_b32 s71, v240, 56
s_pack_ll_b32_b16 s64, s64, s65
s_pack_ll_b32_b16 s65, s66, s67
s_pack_ll_b32_b16 s66, s68, s69
s_pack_ll_b32_b16 s67, s70, s71
v_mov_b32 v240, s64
v_mov_b32 v241, s65
v_mov_b32 v244, s66
v_mov_b32 v245, s67
s_lshl_b32 s72, s2, 5
s_add_u32 s72, s72, 262144
s_waitcnt lgkmcnt(0)
v_mov_b32 v242, s12
v_mov_b32 v243, s13
v_mov_b32 v246, s12
v_mov_b32 v247, s13
s_mov_b64 exec, 1
buffer_store_dwordx4 v[240:243], v122, s[60:63], s72 offen sc1
s_nop 0
buffer_store_dwordx4 v[244:247], v122, s[60:63], s72 offen offset:16 sc1
s_mov_b64 exec, -1
s_branch L_go
P_noz:
s_cmp_ge_u32 s15, 104
s_cbranch_scc1 L_w8
s_mov_b32 s4, 53248
v_mul_lo_u32 v248, v116, s4
v_mul_u32_u24 v249, s68, v117
v_add_u32 v248, v248, v249
s_add_u32 s5, s69, 1
v_cmp_eq_u32 vcc, s69, v123
v_cmp_eq_u32 s[4:5], s5, v123
s_waitcnt vmcnt(0)
ds_read_b64_tr_b16 v[240:241], v121 offset:32768
ds_read_b64_tr_b16 v[242:243], v121 offset:33280
ds_read_b64_tr_b16 v[244:245], v121 offset:33792
ds_read_b64_tr_b16 v[246:247], v121 offset:34304
s_waitcnt lgkmcnt(0)
v_cndmask_b32 v243, 0, v243, vcc
v_cndmask_b32 v247, 0, v247, s[4:5]
buffer_store_dwordx4 v[240:243], v248, s[60:63], s70 offen sc1
buffer_store_dwordx4 v[244:247], v248, s[60:63], s71 offen sc1
s_branch L_go
L_tch:
s_mov_b64 exec, 0
s_cmp_eq_u32 s43, 1
s_cbranch_scc1 TCH_a_1
s_cmp_eq_u32 s43, 2
s_cbranch_scc1 TCH_a_2
s_branch TCH_a_3
RET_a:
s_mov_b64 exec, -1
L_w8:
s_waitcnt vmcnt(2)
L_go:
s_waitcnt vmcnt(4) lgkmcnt(0)
s_barrier
ds_read_b128 v[60:63], v7 offset:0
global_load_dwordx2 v[38:39], v122, s[34:35] sc1
ds_read_b128 v[64:67], v8 offset:0
ds_read_b128 v[68:71], v7 offset:2048
ds_read_b128 v[72:75], v8 offset:2048
s_mov_b64 exec, s[76:77]
ds_read_b128 v[76:79], v11 offset:0
ds_read_b128 v[80:83], v12 offset:0
s_mov_b64 exec, -1
ds_read_b64_tr_b16 v[52:53], v129 offset:12288
ds_read_b64_tr_b16 v[54:55], v129 offset:12416
ds_read_b64_tr_b16 v[56:57], v129 offset:13312
ds_read_b64_tr_b16 v[58:59], v129 offset:13440
ds_read_b32 v16, v145 offset:0
ds_read_b32 v17, v145 offset:16
ds_read_b32 v18, v145 offset:32
ds_read_b32 v19, v145 offset:48
ds_read_b32 v20, v145 offset:64
ds_read_b32 v21, v145 offset:80
ds_read_b32 v22, v145 offset:96
s_waitcnt vmcnt(3) lgkmcnt(0)
s_barrier
s_setprio 3
s_lshl_b32 s4, s43, 10
s_add_u32 m0, s4, 8192
s_add_u32 s4, s4, 262144
buffer_load_dwordx4 v1, s[60:63], s4 offen sc1 lds
v_mfma_f32_16x16x32_bf16 v[192:195], v[52:55], v[60:63], 0
v_mfma_f32_16x16x32_bf16 v[196:199], v[52:55], v[68:71], 0
v_mfma_f32_16x16x32_bf16 v[192:195], v[56:59], v[64:67], v[192:195]
v_mfma_f32_16x16x32_bf16 v[196:199], v[56:59], v[72:75], v[196:199]
s_setprio 0
v_and_b32 v40, -4, v16
v_and_b32 v41, -4, v17
v_and_b32 v42, -4, v18
v_and_b32 v43, -4, v19
v_and_b32 v44, -4, v20
v_and_b32 v45, -4, v21
v_and_b32 v46, -4, v22
v_add_lshl_u32 v16, v40, v16, 1
v_add_lshl_u32 v17, v41, v17, 1
v_add_lshl_u32 v18, v42, v18, 1
v_add_lshl_u32 v19, v43, v19, 1
v_add_lshl_u32 v20, v44, v20, 1
v_add_lshl_u32 v21, v45, v21, 1
v_add_lshl_u32 v22, v46, v22, 1
v_cvt_pk_bf16_f32 v128, v192, v196
v_cvt_pk_bf16_f32 v132, v193, v197
v_cvt_pk_bf16_f32 v136, v194, v198
v_cvt_pk_bf16_f32 v140, v195, v199
ds_read_b128 v[100:103], v7 offset:32768
ds_read_b128 v[104:107], v8 offset:32768
ds_read_b128 v[108:111], v7 offset:34816
ds_read_b128 v[112:115], v8 offset:34816
s_mov_b64 exec, s[74:75]
ds_read_b128 v[76:79], v11 offset:32768
ds_read_b128 v[80:83], v12 offset:32768
s_mov_b64 exec, -1
ds_read_u16 v130, v133 offset:14336
ds_read_u16 v134, v133 offset:14440
ds_read_u16 v138, v133 offset:14544
ds_read_u16 v142, v133 offset:14648
ds_read_u16 v146, v137 offset:14752
ds_read_u16 v150, v137 offset:14856
ds_read_u16 v154, v137 offset:14960
s_waitcnt vmcnt(1) lgkmcnt(0)
s_barrier
L_echk:
v_readfirstlane_b32 s4, v38
v_readfirstlane_b32 s5, v39
s_cmp_eq_u32 s4, 0
s_cbranch_scc1 L_eslow
L_eok:
s_mov_b32 s64, s4
s_mov_b32 s65, s5
v_sub_co_u32 v118, vcc, 0, v38
s_nop 1
v_subb_co_u32 v119, vcc, 0, v39, vcc
s_setprio 3
v_mfma_f32_16x16x32_bf16 v[208:211], v[52:55], v[100:103], 0
v_mfma_f32_16x16x32_bf16 v[212:215], v[52:55], v[108:111], 0
v_mfma_f32_16x16x32_bf16 v[208:211], v[56:59], v[104:107], v[208:211]
v_mfma_f32_16x16x32_bf16 v[212:215], v[56:59], v[112:115], v[212:215]
s_setprio 0
v_lshl_or_b32 v24, v134, 16, v130
v_lshl_or_b32 v25, v142, 16, v138
v_lshl_or_b32 v26, v150, 16, v146
v_mov_b32 v27, v154
s_nop 2
v_cvt_pk_bf16_f32 v144, v208, v212
v_cvt_pk_bf16_f32 v148, v209, v213
v_cvt_pk_bf16_f32 v152, v210, v214
v_cvt_pk_bf16_f32 v156, v211, v215
ds_read_b128 v[60:63], v9 offset:0
ds_read_b128 v[64:67], v10 offset:0
ds_read_b128 v[68:71], v9 offset:2048
ds_read_b128 v[72:75], v10 offset:2048
s_mov_b64 exec, s[76:77]
ds_read_b128 v[84:87], v13 offset:0
ds_read_b128 v[88:91], v14 offset:0
s_mov_b64 exec, -1
ds_read_u16 v162, v141 offset:15360
ds_read_u16 v166, v141 offset:15412
ds_read_u16 v170, v141 offset:15464
ds_read_u16 v174, v141 offset:15516
ds_read_u16 v178, v141 offset:15392
ds_read_u16 v182, v141 offset:15444
ds_read_u16 v186, v141 offset:15496
ds_read_u16 v190, v141 offset:15548
s_waitcnt vmcnt(0) lgkmcnt(0)
s_barrier
s_cmp_lt_u32 s14, 232
s_cbranch_scc1 L_pubx
L_pub:
s_setprio 3
v_mfma_f32_16x16x32_bf16 v[224:227], v[52:55], v[60:63], 0
v_mfma_f32_16x16x32_bf16 v[228:231], v[52:55], v[68:71], 0
v_mfma_f32_16x16x32_bf16 v[224:227], v[56:59], v[64:67], v[224:227]
v_mfma_f32_16x16x32_bf16 v[228:231], v[56:59], v[72:75], v[228:231]
s_setprio 0
s_setprio 3
ds_read_b128 v[100:103], v7 offset:0
ds_read_b128 v[104:107], v8 offset:0
ds_read_b128 v[108:111], v7 offset:2048
ds_read_b128 v[112:115], v8 offset:2048
s_mov_b64 exec, s[74:75]
ds_read_b128 v[84:87], v11 offset:0
ds_read_b128 v[88:91], v12 offset:0
TCH_e_2:
s_cbranch_execz RET_e
s_mov_b64 exec, -1
ds_read_b64 v[40:41], v1 offset:8200
ds_read_b64 v[42:43], v1 offset:9224
ds_read_b64 v[44:45], v1 offset:10248
ds_read_b64 v[46:47], v6 offset:11272
ds_read_u16 v130, v16 offset:8192
ds_read_u16 v134, v17 offset:8192
ds_read_u16 v138, v18 offset:8192
ds_read_u16 v142, v19 offset:8192
ds_read_u16 v146, v20 offset:8192
ds_read_u16 v150, v21 offset:8192
ds_read_u16 v154, v22 offset:8192
s_setprio 0
v_lshl_or_b32 v28, v166, 16, v162
v_lshl_or_b32 v29, v174, 16, v170
v_lshl_or_b32 v30, v182, 16, v178
v_lshl_or_b32 v31, v190, 16, v186
v_cvt_pk_bf16_f32 v160, v224, v228
v_cvt_pk_bf16_f32 v164, v225, v229
v_cvt_pk_bf16_f32 v168, v226, v230
v_cvt_pk_bf16_f32 v172, v227, v231
v_permlane32_swap_b32 v128, v160
v_permlane32_swap_b32 v132, v164
v_permlane32_swap_b32 v136, v168
v_permlane32_swap_b32 v140, v172
s_waitcnt lgkmcnt(0)
L_zchk:
v_lshl_add_u64 v[40:41], v[40:41], 0, v[118:119]
v_lshl_add_u64 v[42:43], v[42:43], 0, v[118:119]
v_lshl_add_u64 v[44:45], v[44:45], 0, v[118:119]
v_lshl_add_u64 v[46:47], v[46:47], 0, v[118:119]
s_mov_b32 s8, 0x4000000
s_mov_b32 s9, 0
v_cmp_lt_u64 vcc, s[8:9], v[40:41]
v_cmp_lt_u64 s[4:5], s[8:9], v[42:43]
v_cmp_lt_u64 s[6:7], s[8:9], v[44:45]
v_cmp_lt_u64 s[8:9], s[8:9], v[46:47]
s_or_b64 s[4:5], s[4:5], vcc
s_or_b64 s[6:7], s[6:7], s[8:9]
s_or_b64 s[4:5], s[4:5], s[6:7]
s_cbranch_scc1 L_zslow
L_zok:
v_lshl_or_b32 v32, v134, 16, v130
v_lshl_or_b32 v33, v142, 16, v138
v_lshl_or_b32 v34, v150, 16, v146
v_mov_b32 v35, v154
s_setprio 3
s_nop 0
v_mfma_f32_16x16x32_bf16 v[40:43], v[24:27], v[32:35], 0
s_setprio 0
v_mov_b32 v23, 0xc0135761
s_waitcnt vmcnt(0) lgkmcnt(0)
s_barrier
s_setprio 3
v_mfma_f32_16x16x32_bf16 v[240:243], v[52:55], v[100:103], 0
v_mfma_f32_16x16x32_bf16 v[244:247], v[52:55], v[108:111], 0
v_mfma_f32_16x16x32_bf16 v[240:243], v[56:59], v[104:107], v[240:243]
v_mfma_f32_16x16x32_bf16 v[244:247], v[56:59], v[112:115], v[244:247]
s_setprio 0
v_mul_f32 v16, v40, v40
v_mul_f32 v17, v41, v41
v_mul_f32 v18, v42, v42
v_mul_f32 v19, v43, v43
v_fma_f32 v16, v16, s73, v23
v_fma_f32 v17, v17, s73, v23
v_fma_f32 v18, v18, s73, v23
v_fma_f32 v19, v19, s73, v23
v_mul_f32 v16, v16, v40
v_mul_f32 v17, v17, v41
v_mul_f32 v18, v18, v42
v_mul_f32 v19, v19, v43
v_exp_f32 v16, v16
v_exp_f32 v17, v17
v_exp_f32 v18, v18
v_exp_f32 v19, v19
v_add_f32 v16, 1.0, v16
v_add_f32 v17, 1.0, v17
v_add_f32 v18, 1.0, v18
v_add_f32 v19, 1.0, v19
v_rcp_f32 v16, v16
v_rcp_f32 v17, v17
v_rcp_f32 v18, v18
v_rcp_f32 v19, v19
v_mul_f32 v40, v40, v16
v_mul_f32 v41, v41, v17
v_mul_f32 v42, v42, v18
v_mul_f32 v43, v43, v19
v_cvt_pk_bf16_f32 v32, v40, v41
v_cvt_pk_bf16_f32 v33, v42, v43
s_setprio 3
s_nop 0
v_mfma_f32_16x16x16_bf16 v[44:47], v[28:29], v[32:33], 0
v_mfma_f32_16x16x16_bf16 v[48:51], v[30:31], v[32:33], 0
s_setprio 3
ds_read_b128 v[60:63], v7 offset:32768
ds_read_b128 v[64:67], v8 offset:32768
ds_read_b128 v[68:71], v7 offset:34816
ds_read_b128 v[72:75], v8 offset:34816
s_mov_b64 exec, s[76:77]
ds_read_b128 v[92:95], v11 offset:32768
ds_read_b128 v[96:99], v12 offset:32768
s_mov_b64 exec, -1
s_setprio 0
s_setprio 0
v_cvt_pk_bf16_f32 v176, v240, v244
v_cvt_pk_bf16_f32 v180, v241, v245
v_cvt_pk_bf16_f32 v184, v242, v246
v_cvt_pk_bf16_f32 v188, v243, v247
v_permlane32_swap_b32 v144, v176
v_permlane32_swap_b32 v148, v180
v_permlane32_swap_b32 v152, v184
v_permlane32_swap_b32 v156, v188
v_permlane16_swap_b32 v128, v144
v_permlane16_swap_b32 v160, v176
v_permlane16_swap_b32 v132, v148
v_permlane16_swap_b32 v164, v180
v_permlane16_swap_b32 v136, v152
v_permlane16_swap_b32 v168, v184
v_permlane16_swap_b32 v140, v156
v_permlane16_swap_b32 v172, v188
s_waitcnt vmcnt(0) lgkmcnt(0)
s_barrier
s_setprio 3
v_mfma_f32_16x16x32_bf16 v[200:203], v[52:55], v[60:63], 0
v_mfma_f32_16x16x32_bf16 v[204:207], v[52:55], v[68:71], 0
v_mfma_f32_16x16x32_bf16 v[200:203], v[56:59], v[64:67], v[200:203]
v_mfma_f32_16x16x32_bf16 v[204:207], v[56:59], v[72:75], v[204:207]
s_setprio 0
v_mul_f32 v44, 0xbfb8aa3b, v44
v_mul_f32 v45, 0xbfb8aa3b, v45
v_mul_f32 v46, 0xbfb8aa3b, v46
v_mul_f32 v47, 0xbfb8aa3b, v47
v_mul_f32 v48, 0xbfb8aa3b, v48
v_mul_f32 v49, 0xbfb8aa3b, v49
v_mul_f32 v50, 0xbfb8aa3b, v50
v_exp_f32 v44, v44
v_exp_f32 v45, v45
v_exp_f32 v46, v46
v_exp_f32 v47, v47
v_exp_f32 v48, v48
v_exp_f32 v49, v49
v_exp_f32 v50, v50
v_add_f32 v44, 1.0, v44
v_add_f32 v45, 1.0, v45
v_add_f32 v46, 1.0, v46
v_add_f32 v47, 1.0, v47
v_add_f32 v48, 1.0, v48
v_add_f32 v49, 1.0, v49
v_add_f32 v50, 1.0, v50
v_rcp_f32 v44, v44
v_rcp_f32 v45, v45
v_rcp_f32 v46, v46
v_rcp_f32 v47, v47
v_rcp_f32 v48, v48
v_rcp_f32 v49, v49
v_rcp_f32 v50, v50
v_cvt_pk_bf16_f32 v129, v200, v204
v_cvt_pk_bf16_f32 v133, v201, v205
s_setprio 3
ds_read_b128 v[100:103], v9 offset:0
ds_read_b128 v[104:107], v10 offset:0
ds_read_b128 v[108:111], v9 offset:2048
ds_read_b128 v[112:115], v10 offset:2048
s_mov_b64 exec, s[74:75]
ds_read_b128 v[92:95], v13 offset:0
ds_read_b128 v[96:99], v14 offset:0
s_mov_b64 exec, -1
s_setprio 0
v_cvt_pk_bf16_f32 v137, v202, v206
v_cvt_pk_bf16_f32 v141, v203, v207
v_mov_b32 v16, v44
v_mov_b32 v20, v46
v_mov_b32 v18, v44
v_mov_b32 v22, v46
s_nop 0
v_permlane32_swap_b32 v16, v18
v_permlane32_swap_b32 v20, v22
v_mov_b32 v17, v16
v_mov_b32 v21, v20
v_mov_b32 v19, v18
v_mov_b32 v23, v22
v_permlane16_swap_b32 v16, v17
TCH_f_3:
s_cbranch_execz RET_f
v_permlane16_swap_b32 v20, v21
v_permlane16_swap_b32 v18, v19
v_permlane16_swap_b32 v22, v23
s_waitcnt vmcnt(0) lgkmcnt(0)
s_barrier
s_setprio 3
v_mfma_f32_16x16x32_bf16 v[216:219], v[52:55], v[100:103], 0
v_mfma_f32_16x16x32_bf16 v[220:223], v[52:55], v[108:111], 0
v_mfma_f32_16x16x32_bf16 v[216:219], v[56:59], v[104:107], v[216:219]
v_mfma_f32_16x16x32_bf16 v[220:223], v[56:59], v[112:115], v[220:223]
s_setprio 0
v_mul_f32 v192, v192, v16
v_mul_f32 v193, v193, v16
v_mul_f32 v194, v194, v16
v_mul_f32 v195, v195, v16
v_mul_f32 v196, v196, v17
v_mul_f32 v197, v197, v17
v_mul_f32 v198, v198, v17
v_mul_f32 v199, v199, v17
v_mul_f32 v200, v200, v20
v_mul_f32 v201, v201, v20
v_mul_f32 v202, v202, v20
v_mul_f32 v203, v203, v20
v_mul_f32 v204, v204, v21
v_mul_f32 v205, v205, v21
v_mul_f32 v206, v206, v21
v_mul_f32 v207, v207, v21
v_cvt_pk_bf16_f32 v192, v192, v196
v_cvt_pk_bf16_f32 v196, v193, v197
v_cvt_pk_bf16_f32 v193, v200, v204
v_cvt_pk_bf16_f32 v197, v201, v205
v_cvt_pk_bf16_f32 v200, v194, v198
v_cvt_pk_bf16_f32 v204, v195, v199
v_cvt_pk_bf16_f32 v201, v202, v206
v_cvt_pk_bf16_f32 v205, v203, v207
v_mov_b32 v40, v48
v_mov_b32 v42, v48
s_nop 1
v_permlane32_swap_b32 v40, v42
v_mov_b32 v41, v40
v_mov_b32 v43, v42
s_nop 0
v_permlane16_swap_b32 v40, v41
v_permlane16_swap_b32 v42, v43
v_cvt_pk_bf16_f32 v145, v216, v220
v_cvt_pk_bf16_f32 v149, v217, v221
v_cvt_pk_bf16_f32 v153, v218, v222
v_cvt_pk_bf16_f32 v157, v219, v223
v_mul_f32 v208, v208, v18
v_mul_f32 v209, v209, v18
v_mul_f32 v210, v210, v18
v_mul_f32 v211, v211, v18
s_setprio 3
ds_read_b128 v[60:63], v7 offset:0
ds_read_b128 v[64:67], v8 offset:0
ds_read_b128 v[68:71], v7 offset:2048
ds_read_b128 v[72:75], v8 offset:2048
s_mov_b64 exec, s[76:77]
ds_read_b128 v[24:27], v11 offset:0
ds_read_b128 v[28:31], v12 offset:0
s_mov_b64 exec, -1
s_setprio 0
v_mul_f32 v212, v212, v19
v_mul_f32 v213, v213, v19
v_mul_f32 v214, v214, v19
v_mul_f32 v215, v215, v19
v_mul_f32 v216, v216, v22
v_mul_f32 v217, v217, v22
v_mul_f32 v218, v218, v22
v_mul_f32 v219, v219, v22
v_mul_f32 v220, v220, v23
v_mul_f32 v221, v221, v23
v_mul_f32 v222, v222, v23
v_mul_f32 v223, v223, v23
v_cvt_pk_bf16_f32 v208, v208, v212
v_cvt_pk_bf16_f32 v212, v209, v213
v_cvt_pk_bf16_f32 v209, v216, v220
v_cvt_pk_bf16_f32 v213, v217, v221
v_cvt_pk_bf16_f32 v216, v210, v214
v_cvt_pk_bf16_f32 v220, v211, v215
v_cvt_pk_bf16_f32 v217, v218, v222
v_cvt_pk_bf16_f32 v221, v219, v223
s_waitcnt vmcnt(0) lgkmcnt(0)
s_barrier
s_setprio 3
v_mfma_f32_16x16x32_bf16 v[232:235], v[52:55], v[60:63], 0
v_mfma_f32_16x16x32_bf16 v[236:239], v[52:55], v[68:71], 0
v_mfma_f32_16x16x32_bf16 v[232:235], v[56:59], v[64:67], v[232:235]
v_mfma_f32_16x16x32_bf16 v[236:239], v[56:59], v[72:75], v[236:239]
s_setprio 0
v_mov_b32 v16, v45
v_mov_b32 v20, v47
v_mov_b32 v18, v45
v_mov_b32 v22, v47
s_nop 0
v_permlane32_swap_b32 v16, v18
v_permlane32_swap_b32 v20, v22
v_mov_b32 v17, v16
v_mov_b32 v21, v20
v_mov_b32 v19, v18
v_mov_b32 v23, v22
v_permlane16_swap_b32 v16, v17
v_permlane16_swap_b32 v20, v21
v_permlane16_swap_b32 v18, v19
v_permlane16_swap_b32 v22, v23
v_cvt_pk_bf16_f32 v161, v232, v236
v_cvt_pk_bf16_f32 v165, v233, v237
v_cvt_pk_bf16_f32 v169, v234, v238
v_cvt_pk_bf16_f32 v173, v235, v239
v_permlane32_swap_b32 v129, v161
v_permlane32_swap_b32 v133, v165
v_permlane32_swap_b32 v137, v169
v_permlane32_swap_b32 v141, v173
v_mul_f32 v224, v224, v16
v_mul_f32 v225, v225, v16
v_mul_f32 v226, v226, v16
v_mul_f32 v227, v227, v16
v_mul_f32 v228, v228, v17
v_mul_f32 v229, v229, v17
v_mul_f32 v230, v230, v17
v_mul_f32 v231, v231, v17
v_mul_f32 v232, v232, v20
v_mul_f32 v233, v233, v20
v_mul_f32 v234, v234, v20
s_setprio 3
ds_read_b128 v[100:103], v7 offset:32768
ds_read_b128 v[104:107], v8 offset:32768
ds_read_b128 v[108:111], v7 offset:34816
ds_read_b128 v[112:115], v8 offset:34816
s_mov_b64 exec, s[74:75]
ds_read_b128 v[24:27], v11 offset:32768
ds_read_b128 v[28:31], v12 offset:32768
s_mov_b64 exec, -1
s_setprio 0
v_mul_f32 v235, v235, v20
v_mul_f32 v236, v236, v21
v_mul_f32 v237, v237, v21
v_mul_f32 v238, v238, v21
v_mul_f32 v239, v239, v21
v_cvt_pk_bf16_f32 v224, v224, v228
v_cvt_pk_bf16_f32 v228, v225, v229
v_cvt_pk_bf16_f32 v225, v232, v236
v_cvt_pk_bf16_f32 v229, v233, v237
v_cvt_pk_bf16_f32 v232, v226, v230
v_cvt_pk_bf16_f32 v236, v227, v231
v_cvt_pk_bf16_f32 v233, v234, v238
v_cvt_pk_bf16_f32 v237, v235, v239
v_permlane32_swap_b32 v192, v224
v_permlane32_swap_b32 v196, v228
v_permlane32_swap_b32 v200, v232
v_permlane32_swap_b32 v204, v236
v_permlane32_swap_b32 v193, v225
v_permlane32_swap_b32 v197, v229
v_permlane32_swap_b32 v201, v233
v_permlane32_swap_b32 v205, v237
s_waitcnt vmcnt(0) lgkmcnt(0)
s_barrier
s_setprio 3
v_mfma_f32_16x16x32_bf16 v[248:251], v[52:55], v[100:103], 0
v_mfma_f32_16x16x32_bf16 v[252:255], v[52:55], v[108:111], 0
v_mfma_f32_16x16x32_bf16 v[248:251], v[56:59], v[104:107], v[248:251]
v_mfma_f32_16x16x32_bf16 v[252:255], v[56:59], v[112:115], v[252:255]
s_setprio 0
s_setprio 3
ds_read_b128 v[60:63], v9 offset:0
ds_read_b128 v[64:67], v10 offset:0
ds_read_b128 v[68:71], v9 offset:2048
ds_read_b128 v[72:75], v10 offset:2048
s_mov_b64 exec, s[76:77]
ds_read_b128 v[116:119], v13 offset:0
ds_read_b128 v[120:123], v14 offset:0
s_mov_b64 exec, -1
s_setprio 0
v_cvt_pk_bf16_f32 v177, v248, v252
v_cvt_pk_bf16_f32 v181, v249, v253
v_cvt_pk_bf16_f32 v185, v250, v254
v_cvt_pk_bf16_f32 v189, v251, v255
v_mul_f32 v240, v240, v18
v_mul_f32 v241, v241, v18
v_mul_f32 v242, v242, v18
v_mul_f32 v243, v243, v18
v_mul_f32 v244, v244, v19
v_mul_f32 v245, v245, v19
v_mul_f32 v246, v246, v19
v_mul_f32 v247, v247, v19
v_mul_f32 v248, v248, v22
v_mul_f32 v249, v249, v22
v_mul_f32 v250, v250, v22
v_mul_f32 v251, v251, v22
TCH_a_2:
s_cbranch_execz TS_5
v_mul_f32 v252, v252, v23
v_mul_f32 v253, v253, v23
v_mul_f32 v254, v254, v23
v_mul_f32 v255, v255, v23
v_cvt_pk_bf16_f32 v240, v240, v244
v_cvt_pk_bf16_f32 v244, v241, v245
v_cvt_pk_bf16_f32 v241, v248, v252
v_cvt_pk_bf16_f32 v245, v249, v253
v_cvt_pk_bf16_f32 v248, v242, v246
v_cvt_pk_bf16_f32 v252, v243, v247
v_cvt_pk_bf16_f32 v249, v250, v254
v_cvt_pk_bf16_f32 v253, v251, v255
s_waitcnt lgkmcnt(0)
s_setprio 3
v_mfma_f32_16x16x32_bf16 v[100:103], v[52:55], v[60:63], 0
v_mfma_f32_16x16x32_bf16 v[104:107], v[52:55], v[68:71], 0
v_mfma_f32_16x16x32_bf16 v[100:103], v[56:59], v[64:67], v[100:103]
v_mfma_f32_16x16x32_bf16 v[104:107], v[56:59], v[72:75], v[104:107]
s_setprio 0
v_permlane32_swap_b32 v145, v177
v_permlane32_swap_b32 v149, v181
v_permlane32_swap_b32 v153, v185
v_permlane32_swap_b32 v157, v189
s_nop 2
v_cvt_pk_bf16_f32 v130, v100, v104
v_cvt_pk_bf16_f32 v134, v101, v105
v_cvt_pk_bf16_f32 v138, v102, v106
v_cvt_pk_bf16_f32 v142, v103, v107
v_mul_f32 v100, v100, v40
v_mul_f32 v101, v101, v40
v_mul_f32 v102, v102, v40
v_mul_f32 v103, v103, v40
v_mul_f32 v104, v104, v41
v_mul_f32 v105, v105, v41
v_mul_f32 v106, v106, v41
v_mul_f32 v107, v107, v41
v_cvt_pk_bf16_f32 v194, v100, v104
v_cvt_pk_bf16_f32 v198, v101, v105
v_cvt_pk_bf16_f32 v202, v102, v106
v_cvt_pk_bf16_f32 v206, v103, v107
s_waitcnt vmcnt(0) lgkmcnt(0)
s_barrier
s_setprio 3
ds_read_b128 v[60:63], v7 offset:0
ds_read_b128 v[64:67], v8 offset:0
ds_read_b128 v[68:71], v7 offset:2048
ds_read_b128 v[72:75], v8 offset:2048
s_mov_b64 exec, s[74:75]
ds_read_b128 v[116:119], v11 offset:0
ds_read_b128 v[120:123], v12 offset:0
s_mov_b64 exec, -1
s_setprio 0
v_permlane16_swap_b32 v129, v145
v_permlane16_swap_b32 v161, v177
v_permlane16_swap_b32 v133, v149
v_permlane16_swap_b32 v165, v181
v_permlane16_swap_b32 v137, v153
v_permlane16_swap_b32 v169, v185
v_permlane16_swap_b32 v141, v157
v_permlane16_swap_b32 v173, v189
v_permlane32_swap_b32 v208, v240
v_permlane32_swap_b32 v212, v244
v_permlane32_swap_b32 v216, v248
v_permlane32_swap_b32 v220, v252
v_permlane32_swap_b32 v209, v241
v_permlane32_swap_b32 v213, v245
v_permlane32_swap_b32 v217, v249
v_permlane32_swap_b32 v221, v253
s_waitcnt lgkmcnt(0)
s_setprio 3
v_mfma_f32_16x16x32_bf16 v[108:111], v[52:55], v[60:63], 0
v_mfma_f32_16x16x32_bf16 v[112:115], v[52:55], v[68:71], 0
v_mfma_f32_16x16x32_bf16 v[108:111], v[56:59], v[64:67], v[108:111]
v_mfma_f32_16x16x32_bf16 v[112:115], v[56:59], v[72:75], v[112:115]
s_setprio 0
v_mov_b32 v20, v49
v_mov_b32 v22, v49
s_nop 1
v_permlane32_swap_b32 v20, v22
v_mov_b32 v21, v20
v_mov_b32 v23, v22
s_nop 0
v_permlane16_swap_b32 v20, v21
v_permlane16_swap_b32 v22, v23
v_cvt_pk_bf16_f32 v146, v108, v112
v_cvt_pk_bf16_f32 v150, v109, v113
v_cvt_pk_bf16_f32 v154, v110, v114
v_cvt_pk_bf16_f32 v158, v111, v115
v_mul_f32 v108, v108, v42
v_mul_f32 v109, v109, v42
v_mul_f32 v110, v110, v42
v_mul_f32 v111, v111, v42
v_mul_f32 v112, v112, v43
v_mul_f32 v113, v113, v43
v_mul_f32 v114, v114, v43
v_mul_f32 v115, v115, v43
v_cvt_pk_bf16_f32 v210, v108, v112
v_cvt_pk_bf16_f32 v214, v109, v113
v_cvt_pk_bf16_f32 v218, v110, v114
v_cvt_pk_bf16_f32 v222, v111, v115
s_waitcnt vmcnt(0) lgkmcnt(0)
s_barrier
s_setprio 3
ds_read_b128 v[60:63], v7 offset:32768
ds_read_b128 v[64:67], v8 offset:32768
ds_read_b128 v[68:71], v7 offset:34816
ds_read_b128 v[72:75], v8 offset:34816
s_mov_b64 exec, s[76:77]
ds_read_b128 v[124:127], v11 offset:32768
ds_read_b128 v[32:35], v12 offset:32768
s_mov_b64 exec, -1
s_setprio 0
v_permlane16_swap_b32 v192, v208
v_permlane16_swap_b32 v224, v240
v_permlane16_swap_b32 v196, v212
v_permlane16_swap_b32 v228, v244
v_permlane16_swap_b32 v200, v216
v_permlane16_swap_b32 v232, v248
v_permlane16_swap_b32 v204, v220
v_permlane16_swap_b32 v236, v252
v_mov_b32 v16, v50
v_mov_b32 v18, v50
s_nop 1
v_permlane32_swap_b32 v16, v18
v_mov_b32 v17, v16
s_nop 1
v_permlane16_swap_b32 v16, v17
s_waitcnt lgkmcnt(0)
s_setprio 3
v_mfma_f32_16x16x32_bf16 v[100:103], v[52:55], v[60:63], 0
v_mfma_f32_16x16x32_bf16 v[104:107], v[52:55], v[68:71], 0
v_mfma_f32_16x16x32_bf16 v[100:103], v[56:59], v[64:67], v[100:103]
v_mfma_f32_16x16x32_bf16 v[104:107], v[56:59], v[72:75], v[104:107]
s_setprio 0
v_permlane16_swap_b32 v193, v209
v_permlane16_swap_b32 v225, v241
v_permlane16_swap_b32 v197, v213
v_permlane16_swap_b32 v229, v245
v_permlane16_swap_b32 v201, v217
v_permlane16_swap_b32 v233, v249
v_permlane16_swap_b32 v205, v221
v_permlane16_swap_b32 v237, v253
v_cvt_pk_bf16_f32 v162, v100, v104
v_cvt_pk_bf16_f32 v166, v101, v105
v_cvt_pk_bf16_f32 v170, v102, v106
v_cvt_pk_bf16_f32 v174, v103, v107
v_mul_f32 v100, v100, v20
v_mul_f32 v101, v101, v20
v_mul_f32 v102, v102, v20
v_mul_f32 v103, v103, v20
v_mul_f32 v104, v104, v21
v_mul_f32 v105, v105, v21
v_mul_f32 v106, v106, v21
v_mul_f32 v107, v107, v21
v_cvt_pk_bf16_f32 v226, v100, v104
v_cvt_pk_bf16_f32 v230, v101, v105
v_cvt_pk_bf16_f32 v234, v102, v106
v_cvt_pk_bf16_f32 v238, v103, v107
s_waitcnt vmcnt(0) lgkmcnt(0)
s_barrier
s_setprio 3
ds_read_b128 v[60:63], v9 offset:0
ds_read_b128 v[64:67], v10 offset:0
ds_read_b128 v[68:71], v9 offset:2048
ds_read_b128 v[72:75], v10 offset:2048
s_mov_b64 exec, s[74:75]
ds_read_b128 v[124:127], v13 offset:0
ds_read_b128 v[32:35], v14 offset:0
s_mov_b64 exec, -1
s_setprio 0
v_permlane32_swap_b32 v130, v162
v_permlane32_swap_b32 v134, v166
v_permlane32_swap_b32 v138, v170
v_permlane32_swap_b32 v142, v174
v_permlane32_swap_b32 v194, v226
v_permlane32_swap_b32 v198, v230
v_permlane32_swap_b32 v202, v234
v_permlane32_swap_b32 v206, v238
s_waitcnt lgkmcnt(0)
s_setprio 3
v_mfma_f32_16x16x32_bf16 v[108:111], v[52:55], v[60:63], 0
v_mfma_f32_16x16x32_bf16 v[112:115], v[52:55], v[68:71], 0
v_mfma_f32_16x16x32_bf16 v[108:111], v[56:59], v[64:67], v[108:111]
v_mfma_f32_16x16x32_bf16 v[112:115], v[56:59], v[72:75], v[112:115]
s_setprio 0
s_nop 7
v_cvt_pk_bf16_f32 v178, v108, v112
v_cvt_pk_bf16_f32 v182, v109, v113
TS_5:
s_cbranch_execz RET_a
v_cvt_pk_bf16_f32 v186, v110, v114
v_cvt_pk_bf16_f32 v190, v111, v115
v_mul_f32 v108, v108, v22
v_mul_f32 v109, v109, v22
v_mul_f32 v110, v110, v22
v_mul_f32 v111, v111, v22
v_mul_f32 v112, v112, v23
v_mul_f32 v113, v113, v23
v_mul_f32 v114, v114, v23
v_mul_f32 v115, v115, v23
v_cvt_pk_bf16_f32 v242, v108, v112
v_cvt_pk_bf16_f32 v246, v109, v113
v_cvt_pk_bf16_f32 v250, v110, v114
v_cvt_pk_bf16_f32 v254, v111, v115
v_mov_b32 v108, 0
v_mov_b32 v109, 0
v_mov_b32 v110, 0
v_mov_b32 v111, 0
v_mov_b32 v112, 0
v_mov_b32 v113, 0
v_mov_b32 v114, 0
v_mov_b32 v115, 0
v_permlane32_swap_b32 v146, v178
v_permlane32_swap_b32 v150, v182
v_permlane32_swap_b32 v154, v186
v_permlane32_swap_b32 v158, v190
v_permlane32_swap_b32 v210, v242
v_permlane32_swap_b32 v214, v246
v_permlane32_swap_b32 v218, v250
v_permlane32_swap_b32 v222, v254
v_permlane16_swap_b32 v130, v146
v_permlane16_swap_b32 v162, v178
v_permlane16_swap_b32 v134, v150
v_permlane16_swap_b32 v166, v182
v_permlane16_swap_b32 v138, v154
v_permlane16_swap_b32 v170, v186
v_permlane16_swap_b32 v142, v158
v_permlane16_swap_b32 v174, v190
v_permlane16_swap_b32 v194, v210
v_permlane16_swap_b32 v226, v242
v_permlane16_swap_b32 v198, v214
v_permlane16_swap_b32 v230, v246
v_permlane16_swap_b32 v202, v218
v_permlane16_swap_b32 v234, v250
v_permlane16_swap_b32 v206, v222
v_permlane16_swap_b32 v238, v254
s_waitcnt vmcnt(0) lgkmcnt(0)
s_barrier
s_setprio 3
ds_read_b128 v[60:63], v7 offset:0
ds_read_b128 v[64:67], v8 offset:0
ds_read_b128 v[68:71], v7 offset:2048
ds_read_b128 v[72:75], v8 offset:2048
s_mov_b64 exec, s[76:77]
ds_read_b128 v[108:111], v11 offset:0
ds_read_b128 v[112:115], v12 offset:0
s_mov_b64 exec, -1
s_waitcnt lgkmcnt(0)
s_setprio 3
v_mfma_f32_16x16x32_bf16 v[100:103], v[52:55], v[60:63], 0
v_mfma_f32_16x16x32_bf16 v[104:107], v[52:55], v[68:71], 0
v_mfma_f32_16x16x32_bf16 v[100:103], v[56:59], v[64:67], v[100:103]
v_mfma_f32_16x16x32_bf16 v[104:107], v[56:59], v[72:75], v[104:107]
s_setprio 0
s_nop 6
v_cvt_pk_bf16_f32 v131, v100, v104
v_cvt_pk_bf16_f32 v135, v101, v105
v_cvt_pk_bf16_f32 v139, v102, v106
v_cvt_pk_bf16_f32 v143, v103, v107
v_mul_f32 v100, v100, v16
v_mul_f32 v101, v101, v16
v_mul_f32 v102, v102, v16
v_mul_f32 v103, v103, v16
s_barrier
ds_read_b128 v[60:63], v4 offset:0
ds_read_b128 v[64:67], v4 offset:1024
ds_read_b128 v[68:71], v4 offset:2048
ds_read_b128 v[72:75], v4 offset:3072
v_mul_f32 v104, v104, v17
v_mul_f32 v105, v105, v17
v_mul_f32 v106, v106, v17
v_mul_f32 v107, v107, v17
v_cvt_pk_bf16_f32 v195, v100, v104
v_cvt_pk_bf16_f32 v199, v101, v105
v_cvt_pk_bf16_f32 v203, v102, v106
v_cvt_pk_bf16_f32 v207, v103, v107
s_waitcnt lgkmcnt(2)
v_mfma_f32_16x16x32_bf16 v[52:55], v[64:67], v[192:195], 0
v_mov_b32 v147, v131
v_mov_b32 v211, v195
v_mfma_f32_16x16x32_bf16 v[56:59], v[60:63], v[128:131], 0
ds_read_b128 v[8:11], v4 offset:4096
ds_read_b128 v[12:15], v4 offset:5120
s_waitcnt lgkmcnt(2)
v_mfma_f32_16x16x32_bf16 v[60:63], v[72:75], v[196:199], 0
v_mov_b32 v151, v135
v_mov_b32 v215, v199
v_mfma_f32_16x16x32_bf16 v[64:67], v[68:71], v[132:135], 0
ds_read_b128 v[68:71], v4 offset:6144
ds_read_b128 v[72:75], v4 offset:7168
v_fmac_f32 v56, v52, v44
v_fmac_f32 v57, v53, v45
v_fmac_f32 v58, v54, v46
v_fmac_f32 v59, v55, v47
s_waitcnt lgkmcnt(2)
v_mfma_f32_16x16x32_bf16 v[52:55], v[12:15], v[200:203], 0
v_mov_b32 v155, v139
v_mov_b32 v219, v203
v_fmac_f32 v64, v60, v44
v_fmac_f32 v65, v61, v45
v_fmac_f32 v66, v62, v46
v_fmac_f32 v67, v63, v47
v_cvt_pk_bf16_f32 v100, v56, v64
v_cvt_pk_bf16_f32 v104, v57, v65
v_cvt_pk_bf16_f32 v16, v58, v66
v_cvt_pk_bf16_f32 v20, v59, v67
v_mfma_f32_16x16x32_bf16 v[60:63], v[8:11], v[136:139], 0
ds_read_b128 v[56:59], v4 offset:8192
ds_read_b128 v[64:67], v4 offset:9216
s_waitcnt lgkmcnt(2)
v_mfma_f32_16x16x32_bf16 v[8:11], v[72:75], v[204:207], 0
v_mov_b32 v159, v143
v_mov_b32 v223, v207
v_mfma_f32_16x16x32_bf16 v[12:15], v[68:71], v[140:143], 0
ds_read_b128 v[68:71], v4 offset:10240
ds_read_b128 v[72:75], v4 offset:11264
v_fmac_f32 v60, v52, v44
v_fmac_f32 v61, v53, v45
v_fmac_f32 v62, v54, v46
v_fmac_f32 v63, v55, v47
s_waitcnt lgkmcnt(2)
v_mfma_f32_16x16x32_bf16 v[52:55], v[64:67], v[208:211], 0
v_mov_b32 v163, v147
v_mov_b32 v227, v211
v_fmac_f32 v12, v8, v44
v_fmac_f32 v13, v9, v45
v_fmac_f32 v14, v10, v46
v_fmac_f32 v15, v11, v47
v_cvt_pk_bf16_f32 v101, v60, v12
v_cvt_pk_bf16_f32 v105, v61, v13
v_cvt_pk_bf16_f32 v17, v62, v14
v_cvt_pk_bf16_f32 v21, v63, v15
v_mfma_f32_16x16x32_bf16 v[8:11], v[56:59], v[144:147], 0
ds_read_b128 v[60:63], v4 offset:12288
ds_read_b128 v[12:15], v4 offset:13312
s_waitcnt lgkmcnt(2)
v_mfma_f32_16x16x32_bf16 v[56:59], v[72:75], v[212:215], 0
v_mov_b32 v167, v151
v_mov_b32 v231, v215
v_mfma_f32_16x16x32_bf16 v[64:67], v[68:71], v[148:151], 0
ds_read_b128 v[68:71], v4 offset:14336
ds_read_b128 v[72:75], v4 offset:15360
v_fmac_f32 v8, v52, v44
v_fmac_f32 v9, v53, v45
v_fmac_f32 v10, v54, v46
v_fmac_f32 v11, v55, v47
s_waitcnt lgkmcnt(2)
v_mfma_f32_16x16x32_bf16 v[52:55], v[12:15], v[216:219], 0
v_mov_b32 v171, v155
v_mov_b32 v235, v219
v_fmac_f32 v64, v56, v44
v_fmac_f32 v65, v57, v45
v_fmac_f32 v66, v58, v46
v_fmac_f32 v67, v59, v47
v_cvt_pk_bf16_f32 v102, v8, v64
v_cvt_pk_bf16_f32 v106, v9, v65
v_cvt_pk_bf16_f32 v18, v10, v66
v_cvt_pk_bf16_f32 v22, v11, v67
v_mfma_f32_16x16x32_bf16 v[56:59], v[60:63], v[152:155], 0
ds_read_b128 v[8:11], v4 offset:16384
ds_read_b128 v[64:67], v4 offset:17408
s_barrier
s_waitcnt lgkmcnt(2)
v_mfma_f32_16x16x32_bf16 v[60:63], v[72:75], v[220:223], 0
v_mov_b32 v175, v159
v_mov_b32 v239, v223
v_mfma_f32_16x16x32_bf16 v[12:15], v[68:71], v[156:159], 0
ds_read_b128 v[68:71], v4 offset:18432
ds_read_b128 v[72:75], v4 offset:19456
v_fmac_f32 v56, v52, v44
v_fmac_f32 v57, v53, v45
v_fmac_f32 v58, v54, v46
TS_6:
s_cbranch_execz RET_a
v_fmac_f32 v59, v55, v47
s_waitcnt lgkmcnt(2)
v_mfma_f32_16x16x32_bf16 v[52:55], v[64:67], v[224:227], 0
v_mov_b32 v179, v163
v_mov_b32 v243, v227
v_fmac_f32 v12, v60, v44
v_fmac_f32 v13, v61, v45
v_fmac_f32 v14, v62, v46
v_fmac_f32 v15, v63, v47
v_cvt_pk_bf16_f32 v103, v56, v12
v_cvt_pk_bf16_f32 v107, v57, v13
v_cvt_pk_bf16_f32 v19, v58, v14
v_cvt_pk_bf16_f32 v23, v59, v15
v_mfma_f32_16x16x32_bf16 v[40:43], v[76:79], v[100:103], 0
v_mfma_f32_16x16x32_bf16 v[40:43], v[84:87], v[104:107], v[40:43]
v_mfma_f32_16x16x32_bf16 v[40:43], v[92:95], v[16:19], v[40:43]
v_mfma_f32_16x16x32_bf16 v[40:43], v[24:27], v[20:23], v[40:43]
v_mfma_f32_16x16x32_bf16 v[60:63], v[8:11], v[160:163], 0
ds_read_b128 v[56:59], v4 offset:20480
ds_read_b128 v[12:15], v4 offset:21504
ds_read_b128 v[76:79], v4 offset:22528
ds_read_b128 v[84:87], v4 offset:23552
s_waitcnt lgkmcnt(4)
v_mfma_f32_16x16x32_bf16 v[92:95], v[72:75], v[228:231], 0
v_mov_b32 v183, v167
v_mov_b32 v247, v231
v_mfma_f32_16x16x32_bf16 v[24:27], v[68:71], v[164:167], 0
v_fmac_f32 v60, v52, v44
v_fmac_f32 v61, v53, v45
v_fmac_f32 v62, v54, v46
v_fmac_f32 v63, v55, v47
s_waitcnt lgkmcnt(2)
v_mfma_f32_16x16x32_bf16 v[8:11], v[12:15], v[232:235], 0
v_mov_b32 v187, v171
v_mov_b32 v251, v235
v_mfma_f32_16x16x32_bf16 v[64:67], v[56:59], v[168:171], 0
ds_read_b128 v[68:71], v4 offset:24576
ds_read_b128 v[72:75], v4 offset:25600
s_waitcnt lgkmcnt(2)
v_mfma_f32_16x16x32_bf16 v[52:55], v[84:87], v[236:239], 0
v_mov_b32 v191, v175
v_mov_b32 v255, v239
v_mfma_f32_16x16x32_bf16 v[56:59], v[76:79], v[172:175], 0
ds_read_b128 v[12:15], v4 offset:26624
ds_read_b128 v[76:79], v4 offset:27648
v_fmac_f32 v24, v92, v44
v_fmac_f32 v25, v93, v45
v_fmac_f32 v26, v94, v46
v_fmac_f32 v27, v95, v47
v_cvt_pk_bf16_f32 v100, v60, v24
v_cvt_pk_bf16_f32 v104, v61, v25
v_cvt_pk_bf16_f32 v16, v62, v26
v_cvt_pk_bf16_f32 v20, v63, v27
s_waitcnt lgkmcnt(2)
v_mfma_f32_16x16x32_bf16 v[84:87], v[72:75], v[240:243], 0
v_fmac_f32 v64, v8, v44
v_fmac_f32 v65, v9, v45
v_mfma_f32_16x16x32_bf16 v[92:95], v[68:71], v[176:179], 0
ds_read_b128 v[60:63], v4 offset:28672
ds_read_b128 v[24:27], v4 offset:29696
v_fmac_f32 v66, v10, v46
v_fmac_f32 v67, v11, v47
s_waitcnt lgkmcnt(2)
v_mfma_f32_16x16x32_bf16 v[68:71], v[76:79], v[244:247], 0
v_fmac_f32 v56, v52, v44
v_fmac_f32 v57, v53, v45
v_mfma_f32_16x16x32_bf16 v[72:75], v[12:15], v[180:183], 0
ds_read_b128 v[8:11], v4 offset:30720
ds_read_b128 v[12:15], v4 offset:31744
v_fmac_f32 v58, v54, v46
v_fmac_f32 v59, v55, v47
v_cvt_pk_bf16_f32 v101, v64, v56
v_cvt_pk_bf16_f32 v105, v65, v57
v_cvt_pk_bf16_f32 v17, v66, v58
v_cvt_pk_bf16_f32 v21, v67, v59
s_waitcnt lgkmcnt(2)
v_mfma_f32_16x16x32_bf16 v[76:79], v[24:27], v[248:251], 0
v_fmac_f32 v92, v84, v44
v_fmac_f32 v93, v85, v45
v_mfma_f32_16x16x32_bf16 v[52:55], v[60:63], v[184:187], 0
ds_read_b128 v[64:67], v5 offset:0
ds_read_b128 v[56:59], v5 offset:640
v_fmac_f32 v94, v86, v46
v_fmac_f32 v95, v87, v47
s_waitcnt lgkmcnt(2)
v_mfma_f32_16x16x32_bf16 v[60:63], v[12:15], v[252:255], 0
v_fmac_f32 v72, v68, v44
v_fmac_f32 v73, v69, v45
v_mfma_f32_16x16x32_bf16 v[24:27], v[8:11], v[188:191], 0
ds_read_b128 v[84:87], v5 offset:1280
ds_read_b128 v[8:11], v5 offset:1920
v_fmac_f32 v74, v70, v46
v_fmac_f32 v75, v71, v47
v_cvt_pk_bf16_f32 v102, v92, v72
v_cvt_pk_bf16_f32 v106, v93, v73
v_cvt_pk_bf16_f32 v18, v94, v74
v_cvt_pk_bf16_f32 v22, v95, v75
s_waitcnt lgkmcnt(2)
v_mfma_f32_16x16x32_bf16 v[12:15], v[56:59], v[192:195], 0
v_fmac_f32 v52, v76, v44
v_fmac_f32 v53, v77, v45
v_mfma_f32_16x16x32_bf16 v[68:71], v[64:67], v[128:131], 0
ds_read_b128 v[92:95], v5 offset:2560
ds_read_b128 v[72:75], v5 offset:3200
v_fmac_f32 v54, v78, v46
v_fmac_f32 v55, v79, v47
s_waitcnt lgkmcnt(2)
v_mfma_f32_16x16x32_bf16 v[64:67], v[8:11], v[196:199], 0
v_fmac_f32 v24, v60, v44
v_fmac_f32 v25, v61, v45
v_mfma_f32_16x16x32_bf16 v[56:59], v[84:87], v[132:135], 0
ds_read_b128 v[128:131], v5 offset:3840
ds_read_b128 v[192:195], v5 offset:4480
v_fmac_f32 v26, v62, v46
v_fmac_f32 v27, v63, v47
v_cvt_pk_bf16_f32 v103, v52, v24
v_cvt_pk_bf16_f32 v107, v53, v25
v_cvt_pk_bf16_f32 v19, v54, v26
v_cvt_pk_bf16_f32 v23, v55, v27
v_mfma_f32_16x16x32_bf16 v[40:43], v[80:83], v[100:103], v[40:43]
v_mfma_f32_16x16x32_bf16 v[40:43], v[88:91], v[104:107], v[40:43]
v_mfma_f32_16x16x32_bf16 v[40:43], v[96:99], v[16:19], v[40:43]
v_mfma_f32_16x16x32_bf16 v[40:43], v[28:31], v[20:23], v[40:43]
ds_read_b128 v[76:79], v5 offset:5120
ds_read_b128 v[84:87], v5 offset:5760
s_waitcnt lgkmcnt(4)
v_mfma_f32_16x16x32_bf16 v[8:11], v[72:75], v[200:203], 0
v_fmac_f32 v68, v12, v48
v_fmac_f32 v69, v13, v49
v_mfma_f32_16x16x32_bf16 v[132:135], v[92:95], v[136:139], 0
v_fmac_f32 v70, v14, v50
ds_read_b128 v[196:199], v5 offset:6400
ds_read_b128 v[60:63], v5 offset:7040
s_waitcnt lgkmcnt(4)
v_mfma_f32_16x16x32_bf16 v[52:55], v[192:195], v[204:207], 0
v_fmac_f32 v56, v64, v48
v_fmac_f32 v57, v65, v49
v_mfma_f32_16x16x32_bf16 v[24:27], v[128:131], v[140:143], 0
v_fmac_f32 v58, v66, v50
v_cvt_pk_bf16_f32 v100, v68, v56
v_cvt_pk_bf16_f32 v104, v69, v57
v_cvt_pk_bf16_f32 v16, v70, v58
ds_read_b128 v[80:83], v5 offset:7680
ds_read_b128 v[88:91], v5 offset:8320
s_waitcnt lgkmcnt(4)
v_mfma_f32_16x16x32_bf16 v[96:99], v[84:87], v[208:211], 0
v_fmac_f32 v132, v8, v48
v_fmac_f32 v133, v9, v49
v_mfma_f32_16x16x32_bf16 v[28:31], v[76:79], v[144:147], 0
v_fmac_f32 v134, v10, v50
ds_read_b128 v[92:95], v5 offset:8960
ds_read_b128 v[72:75], v5 offset:9600
s_waitcnt lgkmcnt(4)
v_mfma_f32_16x16x32_bf16 v[136:139], v[60:63], v[212:215], 0
v_fmac_f32 v24, v52, v48
v_fmac_f32 v25, v53, v49
v_mfma_f32_16x16x32_bf16 v[200:203], v[196:199], v[148:151], 0
v_fmac_f32 v26, v54, v50
v_cvt_pk_bf16_f32 v101, v132, v24
v_cvt_pk_bf16_f32 v105, v133, v25
v_cvt_pk_bf16_f32 v17, v134, v26
ds_read_b128 v[12:15], v5 offset:10240
ds_read_b128 v[128:131], v5 offset:10880
TCH_e_3:
s_cbranch_execz RET_e
s_waitcnt lgkmcnt(4)
v_mfma_f32_16x16x32_bf16 v[192:195], v[88:91], v[216:219], 0
v_fmac_f32 v28, v96, v48
v_fmac_f32 v29, v97, v49
v_mfma_f32_16x16x32_bf16 v[140:143], v[80:83], v[152:155], 0
v_fmac_f32 v30, v98, v50
ds_read_b128 v[204:207], v5 offset:11520
ds_read_b128 v[64:67], v5 offset:12160
s_waitcnt lgkmcnt(4)
v_mfma_f32_16x16x32_bf16 v[68:71], v[72:75], v[220:223], 0
v_fmac_f32 v200, v136, v48
v_fmac_f32 v201, v137, v49
v_mfma_f32_16x16x32_bf16 v[56:59], v[92:95], v[156:159], 0
v_fmac_f32 v202, v138, v50
v_cvt_pk_bf16_f32 v102, v28, v200
v_cvt_pk_bf16_f32 v106, v29, v201
v_cvt_pk_bf16_f32 v18, v30, v202
ds_read_b128 v[76:79], v5 offset:12800
ds_read_b128 v[84:87], v5 offset:13440
s_waitcnt lgkmcnt(4)
v_mfma_f32_16x16x32_bf16 v[144:147], v[128:131], v[224:227], 0
v_fmac_f32 v140, v192, v48
v_fmac_f32 v141, v193, v49
v_mfma_f32_16x16x32_bf16 v[208:211], v[12:15], v[160:163], 0
v_fmac_f32 v142, v194, v50
ds_read_b128 v[8:11], v5 offset:14080
ds_read_b128 v[196:199], v5 offset:14720
s_waitcnt lgkmcnt(4)
v_mfma_f32_16x16x32_bf16 v[60:63], v[64:67], v[228:231], 0
v_fmac_f32 v56, v68, v48
v_fmac_f32 v57, v69, v49
v_mfma_f32_16x16x32_bf16 v[148:151], v[204:207], v[164:167], 0
v_fmac_f32 v58, v70, v50
v_cvt_pk_bf16_f32 v103, v140, v56
v_cvt_pk_bf16_f32 v107, v141, v57
v_cvt_pk_bf16_f32 v19, v142, v58
v_mfma_f32_16x16x32_bf16 v[40:43], v[116:119], v[100:103], v[40:43]
v_mfma_f32_16x16x32_bf16 v[40:43], v[124:127], v[104:107], v[40:43]
v_mfma_f32_16x16x32_bf16 v[40:43], v[108:111], v[16:19], v[40:43]
ds_read_b128 v[212:215], v5 offset:15360
ds_read_b128 v[52:55], v5 offset:16000
s_waitcnt lgkmcnt(4)
v_mfma_f32_16x16x32_bf16 v[132:135], v[84:87], v[232:235], 0
v_fmac_f32 v208, v144, v48
v_fmac_f32 v209, v145, v49
v_mfma_f32_16x16x32_bf16 v[24:27], v[76:79], v[168:171], 0
v_fmac_f32 v210, v146, v50
ds_read_b128 v[80:83], v5 offset:16640
ds_read_b128 v[88:91], v5 offset:17280
s_waitcnt lgkmcnt(4)
v_mfma_f32_16x16x32_bf16 v[152:155], v[196:199], v[236:239], 0
v_fmac_f32 v148, v60, v48
v_fmac_f32 v149, v61, v49
v_mfma_f32_16x16x32_bf16 v[216:219], v[8:11], v[172:175], 0
v_fmac_f32 v150, v62, v50
v_cvt_pk_bf16_f32 v100, v208, v148
v_cvt_pk_bf16_f32 v104, v209, v149
v_cvt_pk_bf16_f32 v16, v210, v150
ds_read_b128 v[96:99], v5 offset:17920
ds_read_b128 v[92:95], v5 offset:18560
s_waitcnt lgkmcnt(4)
v_mfma_f32_16x16x32_bf16 v[72:75], v[52:55], v[240:243], 0
v_fmac_f32 v24, v132, v48
v_fmac_f32 v25, v133, v49
v_mfma_f32_16x16x32_bf16 v[156:159], v[212:215], v[176:179], 0
v_fmac_f32 v26, v134, v50
ds_read_b128 v[220:223], v5 offset:19200
ds_read_b128 v[136:139], v5 offset:19840
s_barrier
ds_read_b32 v36, v2 offset:0
ds_read_b32 v37, v2 offset:256
s_waitcnt lgkmcnt(6)
v_mfma_f32_16x16x32_bf16 v[28:31], v[88:91], v[244:247], 0
v_fmac_f32 v216, v152, v48
v_fmac_f32 v217, v153, v49
v_mfma_f32_16x16x32_bf16 v[200:203], v[80:83], v[180:183], 0
v_fmac_f32 v218, v154, v50
v_cvt_pk_bf16_f32 v101, v24, v216
v_cvt_pk_bf16_f32 v105, v25, v217
v_cvt_pk_bf16_f32 v17, v26, v218
s_waitcnt lgkmcnt(4)
v_mfma_f32_16x16x32_bf16 v[12:15], v[92:95], v[248:251], 0
v_fmac_f32 v156, v72, v48
v_fmac_f32 v157, v73, v49
v_mfma_f32_16x16x32_bf16 v[128:131], v[96:99], v[184:187], 0
v_fmac_f32 v158, v74, v50
s_waitcnt lgkmcnt(2)
v_mfma_f32_16x16x32_bf16 v[160:163], v[136:139], v[252:255], 0
v_fmac_f32 v200, v28, v48
v_fmac_f32 v201, v29, v49
v_mfma_f32_16x16x32_bf16 v[224:227], v[220:223], v[188:191], 0
v_fmac_f32 v202, v30, v50
v_cvt_pk_bf16_f32 v102, v156, v200
v_cvt_pk_bf16_f32 v106, v157, v201
v_cvt_pk_bf16_f32 v18, v158, v202
v_fmac_f32 v128, v12, v48
v_fmac_f32 v129, v13, v49
v_fmac_f32 v130, v14, v50
s_nop 0
v_fmac_f32 v224, v160, v48
v_fmac_f32 v225, v161, v49
v_fmac_f32 v226, v162, v50
v_cvt_pk_bf16_f32 v103, v128, v224
v_cvt_pk_bf16_f32 v107, v129, v225
v_cvt_pk_bf16_f32 v19, v130, v226
v_mfma_f32_16x16x32_bf16 v[40:43], v[120:123], v[100:103], v[40:43]
v_mfma_f32_16x16x32_bf16 v[40:43], v[32:35], v[104:107], v[40:43]
v_mfma_f32_16x16x32_bf16 v[40:43], v[112:115], v[16:19], v[40:43]
s_waitcnt lgkmcnt(0)
v_add_f32 v37, v36, v37
s_mov_b32 s4, 0x22222222
s_mov_b32 s5, s4
s_mov_b32 s6, 0x44444444
s_mov_b32 s7, s6
s_mov_b32 s8, 0x88888888
s_mov_b32 s9, s8
s_lshl_b32 s10, s42, 11
s_add_u32 s10, s10, 327680
s_lshl_b32 s11, s43, 9
s_add_u32 s11, s11, s10
s_lshl_b32 s12, s41, 7
s_add_u32 s11, s11, s12
v_cndmask_b32 v36, v40, v41, s[4:5]
v_cndmask_b32 v36, v36, v42, s[6:7]
v_cndmask_b32 v36, v36, v43, s[8:9]
v_add_f32 v36, v36, v37
s_nop 1
v_mov_b32_dpp v37, v36 quad_perm:[1,0,3,2] row_mask:0xf bank_mask:0xf
s_mov_b32 exec_lo, 0x00500005
s_mov_b32 exec_hi, 0x50000500
buffer_store_dwordx4 v[36:39], v3, s[60:63], s11 offen sc1
s_cmp_lg_u32 s43, s41
s_cbranch_scc1 L_fin
s_mov_b64 exec, s[76:77]
s_lshl_b32 s11, s41, 9
s_add_u32 s11, s11, s10
s_mov_b32 s64, s32
s_mov_b32 s65, s33
s_mov_b32 s66, 8192
s_mov_b32 s67, 0x00020000
L_poll:
buffer_load_dwordx4 v[8:11], v1, s[60:63], s11 offen sc1
s_waitcnt vmcnt(0)
v_cmp_ne_u64 vcc, v[38:39], v[10:11]
v_mov_b32 v16, v8
v_mov_b32 v17, v9
s_cbranch_vccz L_polld
s_add_u32 s3, s3, 1
s_cmp_lt_u32 s3, 200000
s_cbranch_scc1 L_poll
L_polld:
s_mov_b64 exec, -1
s_nop 1
v_add_f32_dpp v16, v16, v16 row_ror:8 row_mask:0xf bank_mask:0xf
v_add_f32_dpp v17, v17, v17 row_ror:8 row_mask:0xf bank_mask:0xf
v_mov_b32 v18, v16
v_mov_b32 v19, v17
s_nop 0
v_permlane16_swap_b32 v16, v18
v_permlane16_swap_b32 v17, v19
v_add_f32 v16, v16, v18
v_add_f32 v17, v17, v19
v_cvt_pk_bf16_f32 v16, v16, v17
v_lshlrev_b32 v5, 2, v0
s_lshl_b32 s4, s2, 5
s_mov_b64 exec, 0xff
buffer_store_dword v16, v5, s[64:67], s4 offen sc1
L_fin:
s_endpgm
L_pubx:
s_cmp_ge_u32 s14, 125
s_cbranch_scc1 L_pubc
s_sub_u32 s6, s12, s64
s_subb_u32 s6, s13, s65
s_cbranch_scc0 L_pub
s_mov_b32 s12, s64
s_mov_b32 s13, s65
v_mov_b32 v242, s12
TCH_f_1:
s_cbranch_execz RET_f
v_mov_b32 v243, s13
v_mov_b32 v246, s12
v_mov_b32 v247, s13
s_mov_b64 exec, 1
buffer_store_dwordx4 v[240:243], v122, s[60:63], s72 offen sc1
buffer_store_dwordx4 v[244:247], v122, s[60:63], s72 offen offset:16 sc1
s_mov_b64 exec, -1
s_branch L_pub
L_pubc:
s_cmp_lt_u32 s14, 128
s_cbranch_scc1 L_pub
s_waitcnt vmcnt(0)
s_mov_b64 exec, 1
buffer_store_dwordx2 v[38:39], v122, s[60:63], s72 offen sc1
s_mov_b64 exec, -1
s_branch L_pub
L_eslow:
s_add_u32 s3, s3, 1
s_cmp_gt_u32 s3, 200000
s_cbranch_scc1 L_eok
global_load_dwordx2 v[38:39], v122, s[34:35] sc1
s_waitcnt vmcnt(0)
s_branch L_echk
L_zslow:
s_add_u32 s3, s3, 1
s_cmp_gt_u32 s3, 200000
s_cbranch_scc1 L_zok
s_mov_b32 s5, m0
s_mov_b32 m0, 8192
s_mov_b32 s4, 262144
buffer_load_dwordx4 v1, s[60:63], s4 offen sc1 lds
buffer_load_dwordx4 v1, s[60:63], s4 offen offset:1024 sc1 lds
buffer_load_dwordx4 v1, s[60:63], s4 offen offset:2048 sc1 lds
buffer_load_dwordx4 v1, s[60:63], s4 offen offset:3072 sc1 lds
s_mov_b32 m0, s5
s_waitcnt vmcnt(0)
ds_read_b64 v[40:41], v1 offset:8200
ds_read_b64 v[42:43], v1 offset:9224
ds_read_b64 v[44:45], v1 offset:10248
ds_read_b64 v[46:47], v6 offset:11272
ds_read_u16 v130, v16 offset:8192
ds_read_u16 v134, v17 offset:8192
ds_read_u16 v138, v18 offset:8192
ds_read_u16 v142, v19 offset:8192
ds_read_u16 v146, v20 offset:8192
ds_read_u16 v150, v21 offset:8192
ds_read_u16 v154, v22 offset:8192
s_waitcnt lgkmcnt(0)
s_branch L_zchk
D_fslow:
s_add_u32 s3, s3, 1
s_cmp_gt_u32 s3, 200000
s_cbranch_scc1 D_fok
global_load_dwordx2 v[206:207], v212, s[34:35] sc1
buffer_load_dwordx2 v[208:209], v213, s[60:63], s11 offen sc1
buffer_load_dwordx2 v[210:211], v214, s[60:63], s11 offen sc1
s_waitcnt vmcnt(0)
s_branch D_fchk
.p2align 10
D_entry:
TCH_e_0:
s_cbranch_execz RET_e
s_nop 0
s_sub_u32 s48, s28, 4096
s_subb_u32 s49, s29, 0
s_mov_b32 s50, 856064
s_mov_b32 s51, 0x00020000
s_waitcnt lgkmcnt(0)
ds_read_b64 v[132:133], v11 offset:16
ds_read_b64 v[158:159], v11 offset:848
ds_read_b64 v[134:135], v11 offset:24
ds_read_b64 v[160:161], v11 offset:856
ds_read_b64 v[136:137], v11 offset:32
ds_read_b64 v[162:163], v11 offset:864
ds_read_b64 v[138:139], v11 offset:40
ds_read_b64 v[164:165], v11 offset:872
ds_read_b64 v[140:141], v11 offset:48
ds_read_b64 v[166:167], v11 offset:880
ds_read_b64 v[142:143], v11 offset:56
ds_read_b64 v[168:169], v11 offset:888
ds_read_b64 v[144:145], v11 offset:64
ds_read_b64 v[170:171], v11 offset:896
s_add_u32 m0, s39, 32768
v_lshl_add_u32 v130, v130, 7, v4
buffer_load_dwordx4 v130, s[44:47], 0 offen lds
v_lshl_add_u32 v156, v156, 7, v5
buffer_load_dwordx4 v156, s[44:47], 0 offen offset:1024 lds
v_lshl_add_u32 v131, v131, 7, v6
buffer_load_dwordx4 v131, s[44:47], 0 offen offset:2048 lds
v_lshl_add_u32 v157, v157, 7, v7
buffer_load_dwordx4 v157, s[44:47], 0 offen offset:3072 lds
s_add_u32 m0, s39, 49152
s_mov_b32 s10, 65536
buffer_load_dwordx4 v2, s[48:51], s10 offen lds
buffer_load_dwordx4 v3, s[48:51], s10 offen offset:1024 lds
s_mov_b32 s10, 96256
buffer_load_dwordx4 v2, s[48:51], s10 offen offset:2048 lds
buffer_load_dwordx4 v3, s[48:51], s10 offen offset:3072 lds
v_lshrrev_b32 v14, 4, v0
v_and_b32 v15, 15, v0
v_lshrrev_b32 v10, 5, v0
v_and_b32 v9, 1, v14
s_and_b32 s6, s43, 1
s_lshl_b32 s4, s6, 13
s_add_u32 s4, s4, 63488
v_lshrrev_b32 v12, 1, v15
v_xor_b32 v13, v12, v10
v_lshlrev_b32 v13, 4, v13
v_lshl_add_u32 v13, v15, 7, v13
v_lshl_add_u32 v13, v9, 12, v13
v_add_u32 v180, s4, v13
v_xor_b32 v181, 32, v180
v_xor_b32 v182, 64, v180
v_xor_b32 v183, 96, v180
s_and_b32 s4, s43, 2
v_or_b32 v12, s4, v9
v_bfe_u32 v13, v0, 3, 1
v_lshlrev_b32 v13, 1, v13
v_xor_b32 v12, v12, v13
v_lshlrev_b32 v184, 5, v12
v_lshl_add_u32 v184, v10, 10, v184
v_bfe_u32 v13, v0, 2, 2
v_lshl_add_u32 v184, v13, 7, v184
v_and_b32 v13, 3, v0
v_lshl_add_u32 v184, v13, 3, v184
v_add_u32 v184, 63488, v184
v_add_u32 v185, 0x10000, v180
v_add_u32 v186, 0x10000, v181
v_add_u32 v187, 0x10000, v182
v_add_u32 v188, 0x10000, v183
v_add_u32 v189, 0x10000, v184
v_mov_b32 v16, 0
v_mov_b32 v17, 0
v_mov_b32 v18, 0
v_mov_b32 v19, 0
v_mov_b32 v20, 0
v_mov_b32 v21, 0
v_mov_b32 v22, 0
v_mov_b32 v23, 0
v_mov_b32 v24, 0
v_mov_b32 v25, 0
v_mov_b32 v26, 0
v_mov_b32 v27, 0
v_mov_b32 v28, 0
v_mov_b32 v29, 0
v_mov_b32 v30, 0
v_mov_b32 v31, 0
s_mov_b32 s76, -1
s_mov_b32 s77, 0
s_mov_b32 s74, 0
s_mov_b32 s75, -1
s_waitcnt lgkmcnt(0)
ds_read_b64 v[146:147], v11 offset:72
ds_read_b64 v[172:173], v11 offset:904
ds_read_b64 v[148:149], v11 offset:80
ds_read_b64 v[174:175], v11 offset:912
ds_read_b64 v[150:151], v11 offset:88
ds_read_b64 v[176:177], v11 offset:920
ds_read_b64 v[152:153], v11 offset:96
ds_read_b64 v[178:179], v11 offset:928
s_lshr_b32 s4, s43, 1
s_lshl_b32 s4, s4, 8
s_lshl_b32 s5, s6, 7
s_add_u32 s4, s4, s5
s_add_u32 s4, s4, 61952
v_lshl_add_u32 v205, v0, 2, s4
s_mov_b32 s73, 0xbdd2d3e8
v_mov_b32 v8, 0xc0135761
s_lshr_b32 s5, s43, 1
s_lshl_b32 s5, s5, 6
s_add_u32 s5, s5, 62464
v_lshl_add_u32 v12, v10, 3, s5
v_mov_b32 v212, 0
v_lshlrev_b32 v213, 5, v0
v_min_u32 v214, 39, v0
v_lshlrev_b32 v214, 5, v214
v_add_u32 v214, 2048, v214
s_mov_b32 s11, 266240
s_mul_i32 s55, s41, 53248
s_lshl_b32 s54, s43, 10
s_add_u32 s55, s55, s54
v_lshl_add_u32 v132, v132, 7, v4
v_lshl_add_u32 v158, v158, 7, v5
v_lshl_add_u32 v133, v133, 7, v6
v_lshl_add_u32 v159, v159, 7, v7
s_mov_b32 s60, s36
s_mov_b32 s61, s37
s_mov_b32 s62, 458752
s_mov_b32 s63, 0x00020000
s_add_u32 m0, s39, 65536
s_waitcnt vmcnt(8) lgkmcnt(0)
s_barrier
buffer_load_dwordx4 v132, s[44:47], 0 offen lds
ds_read_b64_tr_b16 v[80:81], v184 offset:16384
ds_read_b64_tr_b16 v[82:83], v184 offset:16896
ds_read_b128 v[48:51], v180 offset:0
buffer_load_dwordx4 v158, s[44:47], 0 offen offset:1024 lds
ds_read_b64_tr_b16 v[84:85], v184 offset:20480
ds_read_b64_tr_b16 v[86:87], v184 offset:20992
ds_read_b128 v[52:55], v181 offset:0
ds_read_b64_tr_b16 v[96:97], v184 offset:18432
ds_read_b64_tr_b16 v[98:99], v184 offset:18944
ds_read_b128 v[64:67], v180 offset:2048
buffer_load_dwordx4 v133, s[44:47], 0 offen offset:2048 lds
ds_read_b64_tr_b16 v[88:89], v184 offset:24576
ds_read_b64_tr_b16 v[90:91], v184 offset:25088
ds_read_b128 v[56:59], v182 offset:0
ds_read_b64_tr_b16 v[100:101], v184 offset:22528
ds_read_b64_tr_b16 v[102:103], v184 offset:23040
ds_read_b128 v[68:71], v181 offset:2048
buffer_load_dwordx4 v159, s[44:47], 0 offen offset:3072 lds
ds_read_b64_tr_b16 v[92:93], v184 offset:28672
ds_read_b64_tr_b16 v[94:95], v184 offset:29184
ds_read_b128 v[60:63], v183 offset:0
ds_read_b64_tr_b16 v[104:105], v184 offset:26624
ds_read_b64_tr_b16 v[106:107], v184 offset:27136
ds_read_b128 v[72:75], v182 offset:2048
ds_read_b64_tr_b16 v[108:109], v184 offset:30720
ds_read_b64_tr_b16 v[110:111], v184 offset:31232
TCH_e_1:
s_cbranch_execz RET_e
ds_read_b128 v[76:79], v183 offset:2048
s_waitcnt lgkmcnt(15)
v_mfma_f32_32x32x16_bf16 v[16:31], v[80:83], v[48:51], v[16:31]
s_add_u32 m0, s39, 81920
s_mov_b32 s10, 131072
buffer_load_dwordx4 v2, s[48:51], s10 offen lds
s_waitcnt lgkmcnt(15)
v_mfma_f32_32x32x16_bf16 v[16:31], v[84:87], v[52:55], v[16:31]
buffer_load_dwordx4 v3, s[48:51], s10 offen offset:1024 lds
v_lshl_add_u32 v134, v134, 7, v4
v_lshl_add_u32 v160, v160, 7, v5
v_lshl_add_u32 v135, v135, 7, v6
v_lshl_add_u32 v161, v161, 7, v7
s_waitcnt lgkmcnt(12)
v_mfma_f32_32x32x16_bf16 v[16:31], v[88:91], v[56:59], v[16:31]
s_mov_b32 s10, 161792
buffer_load_dwordx4 v2, s[48:51], s10 offen offset:2048 lds
s_waitcnt lgkmcnt(6)
v_mfma_f32_32x32x16_bf16 v[16:31], v[92:95], v[60:63], v[16:31]
buffer_load_dwordx4 v3, s[48:51], s10 offen offset:3072 lds
s_add_u32 m0, s39, 0
s_waitcnt vmcnt(8) lgkmcnt(0)
s_barrier
buffer_load_dwordx4 v134, s[44:47], 0 offen lds
ds_read_b64_tr_b16 v[80:81], v184 offset:49152
ds_read_b64_tr_b16 v[82:83], v184 offset:49664
ds_read_b128 v[48:51], v180 offset:32768
v_mfma_f32_32x32x16_bf16 v[16:31], v[96:99], v[64:67], v[16:31]
buffer_load_dwordx4 v160, s[44:47], 0 offen offset:1024 lds
ds_read_b64_tr_b16 v[84:85], v184 offset:53248
ds_read_b64_tr_b16 v[86:87], v184 offset:53760
ds_read_b128 v[52:55], v181 offset:32768
v_mfma_f32_32x32x16_bf16 v[16:31], v[100:103], v[68:71], v[16:31]
ds_read_b64_tr_b16 v[96:97], v184 offset:51200
ds_read_b64_tr_b16 v[98:99], v184 offset:51712
ds_read_b128 v[64:67], v180 offset:34816
buffer_load_dwordx4 v135, s[44:47], 0 offen offset:2048 lds
ds_read_b64_tr_b16 v[88:89], v184 offset:57344
ds_read_b64_tr_b16 v[90:91], v184 offset:57856
ds_read_b128 v[56:59], v182 offset:32768
v_mfma_f32_32x32x16_bf16 v[16:31], v[104:107], v[72:75], v[16:31]
ds_read_b64_tr_b16 v[100:101], v184 offset:55296
ds_read_b64_tr_b16 v[102:103], v184 offset:55808
ds_read_b128 v[68:71], v181 offset:34816
buffer_load_dwordx4 v161, s[44:47], 0 offen offset:3072 lds
ds_read_b64_tr_b16 v[92:93], v184 offset:61440
ds_read_b64_tr_b16 v[94:95], v184 offset:61952
ds_read_b128 v[60:63], v183 offset:32768
v_mfma_f32_32x32x16_bf16 v[16:31], v[108:111], v[76:79], v[16:31]
ds_read_b64_tr_b16 v[104:105], v184 offset:59392
ds_read_b64_tr_b16 v[106:107], v184 offset:59904
ds_read_b128 v[72:75], v182 offset:34816
ds_read_b64_tr_b16 v[108:109], v184 offset:63488
ds_read_b64_tr_b16 v[110:111], v184 offset:64000
ds_read_b128 v[76:79], v183 offset:34816
s_waitcnt lgkmcnt(15)
v_mfma_f32_32x32x16_bf16 v[16:31], v[80:83], v[48:51], v[16:31]
s_add_u32 m0, s39, 16384
s_mov_b32 s10, 196608
buffer_load_dwordx4 v2, s[48:51], s10 offen lds
s_waitcnt lgkmcnt(15)
v_mfma_f32_32x32x16_bf16 v[16:31], v[84:87], v[52:55], v[16:31]
buffer_load_dwordx4 v3, s[48:51], s10 offen offset:1024 lds
v_lshl_add_u32 v136, v136, 7, v4
v_lshl_add_u32 v162, v162, 7, v5
v_lshl_add_u32 v137, v137, 7, v6
v_lshl_add_u32 v163, v163, 7, v7
s_waitcnt lgkmcnt(12)
v_mfma_f32_32x32x16_bf16 v[16:31], v[88:91], v[56:59], v[16:31]
s_mov_b32 s10, 227328
buffer_load_dwordx4 v2, s[48:51], s10 offen offset:2048 lds
s_waitcnt lgkmcnt(6)
v_mfma_f32_32x32x16_bf16 v[16:31], v[92:95], v[60:63], v[16:31]
buffer_load_dwordx4 v3, s[48:51], s10 offen offset:3072 lds
s_add_u32 m0, s39, 32768
s_waitcnt vmcnt(8) lgkmcnt(0)
s_barrier
buffer_load_dwordx4 v136, s[44:47], 0 offen lds
ds_read_b64_tr_b16 v[80:81], v189 offset:16384
ds_read_b64_tr_b16 v[82:83], v189 offset:16896
ds_read_b128 v[48:51], v185 offset:0
v_mfma_f32_32x32x16_bf16 v[16:31], v[96:99], v[64:67], v[16:31]
buffer_load_dwordx4 v162, s[44:47], 0 offen offset:1024 lds
ds_read_b64_tr_b16 v[84:85], v189 offset:20480
ds_read_b64_tr_b16 v[86:87], v189 offset:20992
ds_read_b128 v[52:55], v186 offset:0
v_mfma_f32_32x32x16_bf16 v[16:31], v[100:103], v[68:71], v[16:31]
ds_read_b64_tr_b16 v[96:97], v189 offset:18432
ds_read_b64_tr_b16 v[98:99], v189 offset:18944
ds_read_b128 v[64:67], v185 offset:2048
buffer_load_dwordx4 v137, s[44:47], 0 offen offset:2048 lds
ds_read_b64_tr_b16 v[88:89], v189 offset:24576
ds_read_b64_tr_b16 v[90:91], v189 offset:25088
ds_read_b128 v[56:59], v187 offset:0
v_mfma_f32_32x32x16_bf16 v[16:31], v[104:107], v[72:75], v[16:31]
ds_read_b64_tr_b16 v[100:101], v189 offset:22528
ds_read_b64_tr_b16 v[102:103], v189 offset:23040
ds_read_b128 v[68:71], v186 offset:2048
buffer_load_dwordx4 v163, s[44:47], 0 offen offset:3072 lds
ds_read_b64_tr_b16 v[92:93], v189 offset:28672
ds_read_b64_tr_b16 v[94:95], v189 offset:29184
ds_read_b128 v[60:63], v188 offset:0
v_mfma_f32_32x32x16_bf16 v[16:31], v[108:111], v[76:79], v[16:31]
ds_read_b64_tr_b16 v[104:105], v189 offset:26624
ds_read_b64_tr_b16 v[106:107], v189 offset:27136
ds_read_b128 v[72:75], v187 offset:2048
ds_read_b64_tr_b16 v[108:109], v189 offset:30720
ds_read_b64_tr_b16 v[110:111], v189 offset:31232
ds_read_b128 v[76:79], v188 offset:2048
s_waitcnt lgkmcnt(15)
v_mfma_f32_32x32x16_bf16 v[16:31], v[80:83], v[48:51], v[16:31]
s_add_u32 m0, s39, 49152
s_mov_b32 s10, 262144
buffer_load_dwordx4 v2, s[48:51], s10 offen lds
s_waitcnt lgkmcnt(15)
v_mfma_f32_32x32x16_bf16 v[16:31], v[84:87], v[52:55], v[16:31]
buffer_load_dwordx4 v3, s[48:51], s10 offen offset:1024 lds
v_lshl_add_u32 v138, v138, 7, v4
v_lshl_add_u32 v164, v164, 7, v5
v_lshl_add_u32 v139, v139, 7, v6
v_lshl_add_u32 v165, v165, 7, v7
s_waitcnt lgkmcnt(12)
v_mfma_f32_32x32x16_bf16 v[16:31], v[88:91], v[56:59], v[16:31]
s_mov_b32 s10, 292864
buffer_load_dwordx4 v2, s[48:51], s10 offen offset:2048 lds
s_waitcnt lgkmcnt(6)
v_mfma_f32_32x32x16_bf16 v[16:31], v[92:95], v[60:63], v[16:31]
buffer_load_dwordx4 v3, s[48:51], s10 offen offset:3072 lds
s_add_u32 m0, s39, 65536
s_waitcnt vmcnt(8) lgkmcnt(0)
s_barrier
buffer_load_dwordx4 v138, s[44:47], 0 offen lds
ds_read_b64_tr_b16 v[80:81], v184 offset:16384
ds_read_b64_tr_b16 v[82:83], v184 offset:16896
ds_read_b128 v[48:51], v180 offset:0
v_mfma_f32_32x32x16_bf16 v[16:31], v[96:99], v[64:67], v[16:31]
buffer_load_dwordx4 v164, s[44:47], 0 offen offset:1024 lds
TCH_f_2:
s_cbranch_execz RET_f
ds_read_b64_tr_b16 v[84:85], v184 offset:20480
ds_read_b64_tr_b16 v[86:87], v184 offset:20992
ds_read_b128 v[52:55], v181 offset:0
v_mfma_f32_32x32x16_bf16 v[16:31], v[100:103], v[68:71], v[16:31]
ds_read_b64_tr_b16 v[96:97], v184 offset:18432
ds_read_b64_tr_b16 v[98:99], v184 offset:18944
ds_read_b128 v[64:67], v180 offset:2048
buffer_load_dwordx4 v139, s[44:47], 0 offen offset:2048 lds
ds_read_b64_tr_b16 v[88:89], v184 offset:24576
ds_read_b64_tr_b16 v[90:91], v184 offset:25088
ds_read_b128 v[56:59], v182 offset:0
v_mfma_f32_32x32x16_bf16 v[16:31], v[104:107], v[72:75], v[16:31]
ds_read_b64_tr_b16 v[100:101], v184 offset:22528
ds_read_b64_tr_b16 v[102:103], v184 offset:23040
ds_read_b128 v[68:71], v181 offset:2048
buffer_load_dwordx4 v165, s[44:47], 0 offen offset:3072 lds
ds_read_b64_tr_b16 v[92:93], v184 offset:28672
ds_read_b64_tr_b16 v[94:95], v184 offset:29184
ds_read_b128 v[60:63], v183 offset:0
v_mfma_f32_32x32x16_bf16 v[16:31], v[108:111], v[76:79], v[16:31]
ds_read_b64_tr_b16 v[104:105], v184 offset:26624
ds_read_b64_tr_b16 v[106:107], v184 offset:27136
ds_read_b128 v[72:75], v182 offset:2048
ds_read_b64_tr_b16 v[108:109], v184 offset:30720
ds_read_b64_tr_b16 v[110:111], v184 offset:31232
ds_read_b128 v[76:79], v183 offset:2048
s_waitcnt lgkmcnt(15)
v_mfma_f32_32x32x16_bf16 v[16:31], v[80:83], v[48:51], v[16:31]
s_add_u32 m0, s39, 81920
s_mov_b32 s10, 327680
buffer_load_dwordx4 v2, s[48:51], s10 offen lds
s_waitcnt lgkmcnt(15)
v_mfma_f32_32x32x16_bf16 v[16:31], v[84:87], v[52:55], v[16:31]
buffer_load_dwordx4 v3, s[48:51], s10 offen offset:1024 lds
v_lshl_add_u32 v140, v140, 7, v4
v_lshl_add_u32 v166, v166, 7, v5
v_lshl_add_u32 v141, v141, 7, v6
v_lshl_add_u32 v167, v167, 7, v7
s_waitcnt lgkmcnt(12)
v_mfma_f32_32x32x16_bf16 v[16:31], v[88:91], v[56:59], v[16:31]
s_mov_b32 s10, 358400
buffer_load_dwordx4 v2, s[48:51], s10 offen offset:2048 lds
s_waitcnt lgkmcnt(6)
v_mfma_f32_32x32x16_bf16 v[16:31], v[92:95], v[60:63], v[16:31]
buffer_load_dwordx4 v3, s[48:51], s10 offen offset:3072 lds
ds_read_b64 v[240:241], v12 offset:0
ds_read_b64 v[242:243], v12 offset:16
ds_read_b64 v[244:245], v12 offset:32
ds_read_b64 v[246:247], v12 offset:48
s_add_u32 m0, s39, 0
s_waitcnt vmcnt(8) lgkmcnt(0)
s_barrier
buffer_load_dwordx4 v140, s[44:47], 0 offen lds
ds_read_b64_tr_b16 v[80:81], v184 offset:49152
ds_read_b64_tr_b16 v[82:83], v184 offset:49664
ds_read_b128 v[48:51], v180 offset:32768
v_mfma_f32_32x32x16_bf16 v[16:31], v[96:99], v[64:67], v[16:31]
buffer_load_dwordx4 v166, s[44:47], 0 offen offset:1024 lds
ds_read_b64_tr_b16 v[84:85], v184 offset:53248
ds_read_b64_tr_b16 v[86:87], v184 offset:53760
ds_read_b128 v[52:55], v181 offset:32768
v_mfma_f32_32x32x16_bf16 v[16:31], v[100:103], v[68:71], v[16:31]
ds_read_b64_tr_b16 v[96:97], v184 offset:51200
ds_read_b64_tr_b16 v[98:99], v184 offset:51712
ds_read_b128 v[64:67], v180 offset:34816
buffer_load_dwordx4 v141, s[44:47], 0 offen offset:2048 lds
ds_read_b64_tr_b16 v[88:89], v184 offset:57344
ds_read_b64_tr_b16 v[90:91], v184 offset:57856
ds_read_b128 v[56:59], v182 offset:32768
v_mfma_f32_32x32x16_bf16 v[16:31], v[104:107], v[72:75], v[16:31]
ds_read_b64_tr_b16 v[100:101], v184 offset:55296
ds_read_b64_tr_b16 v[102:103], v184 offset:55808
ds_read_b128 v[68:71], v181 offset:34816
buffer_load_dwordx4 v167, s[44:47], 0 offen offset:3072 lds
ds_read_b64_tr_b16 v[92:93], v184 offset:61440
ds_read_b64_tr_b16 v[94:95], v184 offset:61952
ds_read_b128 v[60:63], v183 offset:32768
v_mfma_f32_32x32x16_bf16 v[16:31], v[108:111], v[76:79], v[16:31]
ds_read_b64_tr_b16 v[104:105], v184 offset:59392
ds_read_b64_tr_b16 v[106:107], v184 offset:59904
ds_read_b128 v[72:75], v182 offset:34816
ds_read_b64_tr_b16 v[108:109], v184 offset:63488
ds_read_b64_tr_b16 v[110:111], v184 offset:64000
ds_read_b128 v[76:79], v183 offset:34816
s_waitcnt lgkmcnt(15)
v_mfma_f32_32x32x16_bf16 v[16:31], v[80:83], v[48:51], v[16:31]
s_add_u32 m0, s39, 16384
s_mov_b32 s10, 393216
buffer_load_dwordx4 v2, s[48:51], s10 offen lds
s_waitcnt lgkmcnt(15)
v_mfma_f32_32x32x16_bf16 v[16:31], v[84:87], v[52:55], v[16:31]
buffer_load_dwordx4 v3, s[48:51], s10 offen offset:1024 lds
v_lshl_add_u32 v142, v142, 7, v4
v_lshl_add_u32 v168, v168, 7, v5
v_lshl_add_u32 v143, v143, 7, v6
v_lshl_add_u32 v169, v169, 7, v7
s_waitcnt lgkmcnt(12)
v_mfma_f32_32x32x16_bf16 v[16:31], v[88:91], v[56:59], v[16:31]
s_mov_b32 s10, 423936
buffer_load_dwordx4 v2, s[48:51], s10 offen offset:2048 lds
s_waitcnt lgkmcnt(6)
v_mfma_f32_32x32x16_bf16 v[16:31], v[92:95], v[60:63], v[16:31]
buffer_load_dwordx4 v3, s[48:51], s10 offen offset:3072 lds
s_add_u32 m0, s39, 32768
s_waitcnt vmcnt(8) lgkmcnt(0)
s_barrier
buffer_load_dwordx4 v142, s[44:47], 0 offen lds
ds_read_b64_tr_b16 v[80:81], v189 offset:16384
ds_read_b64_tr_b16 v[82:83], v189 offset:16896
ds_read_b128 v[48:51], v185 offset:0
v_mfma_f32_32x32x16_bf16 v[16:31], v[96:99], v[64:67], v[16:31]
buffer_load_dwordx4 v168, s[44:47], 0 offen offset:1024 lds
ds_read_b64_tr_b16 v[84:85], v189 offset:20480
ds_read_b64_tr_b16 v[86:87], v189 offset:20992
ds_read_b128 v[52:55], v186 offset:0
v_mfma_f32_32x32x16_bf16 v[16:31], v[100:103], v[68:71], v[16:31]
ds_read_b64_tr_b16 v[96:97], v189 offset:18432
ds_read_b64_tr_b16 v[98:99], v189 offset:18944
ds_read_b128 v[64:67], v185 offset:2048
buffer_load_dwordx4 v143, s[44:47], 0 offen offset:2048 lds
ds_read_b64_tr_b16 v[88:89], v189 offset:24576
ds_read_b64_tr_b16 v[90:91], v189 offset:25088
ds_read_b128 v[56:59], v187 offset:0
v_mfma_f32_32x32x16_bf16 v[16:31], v[104:107], v[72:75], v[16:31]
ds_read_b64_tr_b16 v[100:101], v189 offset:22528
ds_read_b64_tr_b16 v[102:103], v189 offset:23040
ds_read_b128 v[68:71], v186 offset:2048
buffer_load_dwordx4 v169, s[44:47], 0 offen offset:3072 lds
ds_read_b64_tr_b16 v[92:93], v189 offset:28672
ds_read_b64_tr_b16 v[94:95], v189 offset:29184
ds_read_b128 v[60:63], v188 offset:0
v_mfma_f32_32x32x16_bf16 v[16:31], v[108:111], v[76:79], v[16:31]
ds_read_b64_tr_b16 v[104:105], v189 offset:26624
ds_read_b64_tr_b16 v[106:107], v189 offset:27136
TCH_a_1:
s_cbranch_execz TS_14
ds_read_b128 v[72:75], v187 offset:2048
ds_read_b64_tr_b16 v[108:109], v189 offset:30720
ds_read_b64_tr_b16 v[110:111], v189 offset:31232
ds_read_b128 v[76:79], v188 offset:2048
s_waitcnt lgkmcnt(15)
v_mfma_f32_32x32x16_bf16 v[16:31], v[80:83], v[48:51], v[16:31]
s_add_u32 m0, s39, 49152
s_mov_b32 s10, 458752
buffer_load_dwordx4 v2, s[48:51], s10 offen lds
s_waitcnt lgkmcnt(15)
v_mfma_f32_32x32x16_bf16 v[16:31], v[84:87], v[52:55], v[16:31]
buffer_load_dwordx4 v3, s[48:51], s10 offen offset:1024 lds
v_lshl_add_u32 v144, v144, 7, v4
v_lshl_add_u32 v170, v170, 7, v5
v_lshl_add_u32 v145, v145, 7, v6
v_lshl_add_u32 v171, v171, 7, v7
s_waitcnt lgkmcnt(12)
v_mfma_f32_32x32x16_bf16 v[16:31], v[88:91], v[56:59], v[16:31]
s_mov_b32 s10, 489472
buffer_load_dwordx4 v2, s[48:51], s10 offen offset:2048 lds
s_waitcnt lgkmcnt(6)
v_mfma_f32_32x32x16_bf16 v[16:31], v[92:95], v[60:63], v[16:31]
buffer_load_dwordx4 v3, s[48:51], s10 offen offset:3072 lds
s_add_u32 m0, s39, 65536
s_waitcnt vmcnt(8) lgkmcnt(0)
s_barrier
buffer_load_dwordx4 v144, s[44:47], 0 offen lds
ds_read_b64_tr_b16 v[80:81], v184 offset:16384
ds_read_b64_tr_b16 v[82:83], v184 offset:16896
ds_read_b128 v[48:51], v180 offset:0
v_mfma_f32_32x32x16_bf16 v[16:31], v[96:99], v[64:67], v[16:31]
buffer_load_dwordx4 v170, s[44:47], 0 offen offset:1024 lds
ds_read_b64_tr_b16 v[84:85], v184 offset:20480
ds_read_b64_tr_b16 v[86:87], v184 offset:20992
ds_read_b128 v[52:55], v181 offset:0
v_mfma_f32_32x32x16_bf16 v[16:31], v[100:103], v[68:71], v[16:31]
ds_read_b64_tr_b16 v[96:97], v184 offset:18432
ds_read_b64_tr_b16 v[98:99], v184 offset:18944
ds_read_b128 v[64:67], v180 offset:2048
buffer_load_dwordx4 v145, s[44:47], 0 offen offset:2048 lds
ds_read_b64_tr_b16 v[88:89], v184 offset:24576
ds_read_b64_tr_b16 v[90:91], v184 offset:25088
ds_read_b128 v[56:59], v182 offset:0
v_mfma_f32_32x32x16_bf16 v[16:31], v[104:107], v[72:75], v[16:31]
ds_read_b64_tr_b16 v[100:101], v184 offset:22528
ds_read_b64_tr_b16 v[102:103], v184 offset:23040
ds_read_b128 v[68:71], v181 offset:2048
buffer_load_dwordx4 v171, s[44:47], 0 offen offset:3072 lds
ds_read_b64_tr_b16 v[92:93], v184 offset:28672
ds_read_b64_tr_b16 v[94:95], v184 offset:29184
ds_read_b128 v[60:63], v183 offset:0
v_mfma_f32_32x32x16_bf16 v[16:31], v[108:111], v[76:79], v[16:31]
ds_read_b64_tr_b16 v[104:105], v184 offset:26624
ds_read_b64_tr_b16 v[106:107], v184 offset:27136
ds_read_b128 v[72:75], v182 offset:2048
ds_read_b64_tr_b16 v[108:109], v184 offset:30720
ds_read_b64_tr_b16 v[110:111], v184 offset:31232
ds_read_b128 v[76:79], v183 offset:2048
s_waitcnt lgkmcnt(15)
v_mfma_f32_32x32x16_bf16 v[16:31], v[80:83], v[48:51], v[16:31]
s_add_u32 m0, s39, 81920
s_mov_b32 s10, 524288
buffer_load_dwordx4 v2, s[48:51], s10 offen lds
s_waitcnt lgkmcnt(15)
v_mfma_f32_32x32x16_bf16 v[16:31], v[84:87], v[52:55], v[16:31]
buffer_load_dwordx4 v3, s[48:51], s10 offen offset:1024 lds
v_lshl_add_u32 v146, v146, 7, v4
v_lshl_add_u32 v172, v172, 7, v5
v_lshl_add_u32 v147, v147, 7, v6
v_lshl_add_u32 v173, v173, 7, v7
s_waitcnt lgkmcnt(12)
v_mfma_f32_32x32x16_bf16 v[16:31], v[88:91], v[56:59], v[16:31]
s_mov_b32 s10, 555008
buffer_load_dwordx4 v2, s[48:51], s10 offen offset:2048 lds
s_waitcnt lgkmcnt(6)
v_mfma_f32_32x32x16_bf16 v[16:31], v[92:95], v[60:63], v[16:31]
buffer_load_dwordx4 v3, s[48:51], s10 offen offset:3072 lds
s_add_u32 m0, s39, 0
s_waitcnt vmcnt(8) lgkmcnt(0)
s_barrier
buffer_load_dwordx4 v146, s[44:47], 0 offen lds
ds_read_b64_tr_b16 v[80:81], v184 offset:49152
ds_read_b64_tr_b16 v[82:83], v184 offset:49664
ds_read_b128 v[48:51], v180 offset:32768
v_mfma_f32_32x32x16_bf16 v[16:31], v[96:99], v[64:67], v[16:31]
buffer_load_dwordx4 v172, s[44:47], 0 offen offset:1024 lds
ds_read_b64_tr_b16 v[84:85], v184 offset:53248
ds_read_b64_tr_b16 v[86:87], v184 offset:53760
ds_read_b128 v[52:55], v181 offset:32768
v_mfma_f32_32x32x16_bf16 v[16:31], v[100:103], v[68:71], v[16:31]
ds_read_b64_tr_b16 v[96:97], v184 offset:51200
ds_read_b64_tr_b16 v[98:99], v184 offset:51712
ds_read_b128 v[64:67], v180 offset:34816
buffer_load_dwordx4 v147, s[44:47], 0 offen offset:2048 lds
ds_read_b64_tr_b16 v[88:89], v184 offset:57344
ds_read_b64_tr_b16 v[90:91], v184 offset:57856
ds_read_b128 v[56:59], v182 offset:32768
v_mfma_f32_32x32x16_bf16 v[16:31], v[104:107], v[72:75], v[16:31]
ds_read_b64_tr_b16 v[100:101], v184 offset:55296
ds_read_b64_tr_b16 v[102:103], v184 offset:55808
ds_read_b128 v[68:71], v181 offset:34816
buffer_load_dwordx4 v173, s[44:47], 0 offen offset:3072 lds
ds_read_b64_tr_b16 v[92:93], v184 offset:61440
ds_read_b64_tr_b16 v[94:95], v184 offset:61952
ds_read_b128 v[60:63], v183 offset:32768
v_mfma_f32_32x32x16_bf16 v[16:31], v[108:111], v[76:79], v[16:31]
ds_read_b64_tr_b16 v[104:105], v184 offset:59392
ds_read_b64_tr_b16 v[106:107], v184 offset:59904
ds_read_b128 v[72:75], v182 offset:34816
ds_read_b64_tr_b16 v[108:109], v184 offset:63488
ds_read_b64_tr_b16 v[110:111], v184 offset:64000
ds_read_b128 v[76:79], v183 offset:34816
s_waitcnt lgkmcnt(15)
v_mfma_f32_32x32x16_bf16 v[16:31], v[80:83], v[48:51], v[16:31]
s_add_u32 m0, s39, 16384
s_mov_b32 s10, 589824
buffer_load_dwordx4 v2, s[48:51], s10 offen lds
s_waitcnt lgkmcnt(15)
v_mfma_f32_32x32x16_bf16 v[16:31], v[84:87], v[52:55], v[16:31]
buffer_load_dwordx4 v3, s[48:51], s10 offen offset:1024 lds
v_lshl_add_u32 v148, v148, 7, v4
v_lshl_add_u32 v174, v174, 7, v5
v_lshl_add_u32 v149, v149, 7, v6
v_lshl_add_u32 v175, v175, 7, v7
s_waitcnt lgkmcnt(12)
v_mfma_f32_32x32x16_bf16 v[16:31], v[88:91], v[56:59], v[16:31]
s_mov_b32 s10, 620544
buffer_load_dwordx4 v2, s[48:51], s10 offen offset:2048 lds
s_waitcnt lgkmcnt(6)
v_mfma_f32_32x32x16_bf16 v[16:31], v[92:95], v[60:63], v[16:31]
buffer_load_dwordx4 v3, s[48:51], s10 offen offset:3072 lds
s_add_u32 m0, s39, 32768
s_waitcnt vmcnt(8) lgkmcnt(0)
s_barrier
buffer_load_dwordx4 v148, s[44:47], 0 offen lds
ds_read_b64_tr_b16 v[80:81], v189 offset:16384
ds_read_b64_tr_b16 v[82:83], v189 offset:16896
TCH_a_3:
s_cbranch_execz TS_6
ds_read_b128 v[48:51], v185 offset:0
v_mfma_f32_32x32x16_bf16 v[16:31], v[96:99], v[64:67], v[16:31]
buffer_load_dwordx4 v174, s[44:47], 0 offen offset:1024 lds
ds_read_b64_tr_b16 v[84:85], v189 offset:20480
ds_read_b64_tr_b16 v[86:87], v189 offset:20992
ds_read_b128 v[52:55], v186 offset:0
v_mfma_f32_32x32x16_bf16 v[16:31], v[100:103], v[68:71], v[16:31]
ds_read_b64_tr_b16 v[96:97], v189 offset:18432
ds_read_b64_tr_b16 v[98:99], v189 offset:18944
ds_read_b128 v[64:67], v185 offset:2048
buffer_load_dwordx4 v149, s[44:47], 0 offen offset:2048 lds
ds_read_b64_tr_b16 v[88:89], v189 offset:24576
ds_read_b64_tr_b16 v[90:91], v189 offset:25088
ds_read_b128 v[56:59], v187 offset:0
v_mfma_f32_32x32x16_bf16 v[16:31], v[104:107], v[72:75], v[16:31]
ds_read_b64_tr_b16 v[100:101], v189 offset:22528
ds_read_b64_tr_b16 v[102:103], v189 offset:23040
ds_read_b128 v[68:71], v186 offset:2048
buffer_load_dwordx4 v175, s[44:47], 0 offen offset:3072 lds
ds_read_b64_tr_b16 v[92:93], v189 offset:28672
ds_read_b64_tr_b16 v[94:95], v189 offset:29184
ds_read_b128 v[60:63], v188 offset:0
v_mfma_f32_32x32x16_bf16 v[16:31], v[108:111], v[76:79], v[16:31]
ds_read_b64_tr_b16 v[104:105], v189 offset:26624
ds_read_b64_tr_b16 v[106:107], v189 offset:27136
ds_read_b128 v[72:75], v187 offset:2048
ds_read_b64_tr_b16 v[108:109], v189 offset:30720
ds_read_b64_tr_b16 v[110:111], v189 offset:31232
ds_read_b128 v[76:79], v188 offset:2048
s_waitcnt lgkmcnt(15)
v_mfma_f32_32x32x16_bf16 v[16:31], v[80:83], v[48:51], v[16:31]
s_add_u32 m0, s39, 49152
s_mov_b32 s10, 655360
buffer_load_dwordx4 v2, s[48:51], s10 offen lds
s_waitcnt lgkmcnt(15)
v_mfma_f32_32x32x16_bf16 v[16:31], v[84:87], v[52:55], v[16:31]
buffer_load_dwordx4 v3, s[48:51], s10 offen offset:1024 lds
v_lshl_add_u32 v150, v150, 7, v4
v_lshl_add_u32 v176, v176, 7, v5
v_lshl_add_u32 v151, v151, 7, v6
v_lshl_add_u32 v177, v177, 7, v7
s_waitcnt lgkmcnt(12)
v_mfma_f32_32x32x16_bf16 v[16:31], v[88:91], v[56:59], v[16:31]
s_mov_b32 s10, 686080
buffer_load_dwordx4 v2, s[48:51], s10 offen offset:2048 lds
s_waitcnt lgkmcnt(6)
v_mfma_f32_32x32x16_bf16 v[16:31], v[92:95], v[60:63], v[16:31]
buffer_load_dwordx4 v3, s[48:51], s10 offen offset:3072 lds
global_load_dwordx2 v[206:207], v212, s[34:35] sc1
buffer_load_dwordx2 v[208:209], v213, s[60:63], s11 offen sc1
buffer_load_dwordx2 v[210:211], v214, s[60:63], s11 offen sc1
s_add_u32 m0, s39, 65536
s_waitcnt vmcnt(11) lgkmcnt(0)
s_barrier
buffer_load_dwordx4 v150, s[44:47], 0 offen lds
ds_read_b64_tr_b16 v[80:81], v184 offset:16384
ds_read_b64_tr_b16 v[82:83], v184 offset:16896
ds_read_b128 v[48:51], v180 offset:0
v_mfma_f32_32x32x16_bf16 v[16:31], v[96:99], v[64:67], v[16:31]
buffer_load_dwordx4 v176, s[44:47], 0 offen offset:1024 lds
ds_read_b64_tr_b16 v[84:85], v184 offset:20480
ds_read_b64_tr_b16 v[86:87], v184 offset:20992
ds_read_b128 v[52:55], v181 offset:0
v_mfma_f32_32x32x16_bf16 v[16:31], v[100:103], v[68:71], v[16:31]
ds_read_b64_tr_b16 v[96:97], v184 offset:18432
ds_read_b64_tr_b16 v[98:99], v184 offset:18944
ds_read_b128 v[64:67], v180 offset:2048
buffer_load_dwordx4 v151, s[44:47], 0 offen offset:2048 lds
ds_read_b64_tr_b16 v[88:89], v184 offset:24576
ds_read_b64_tr_b16 v[90:91], v184 offset:25088
ds_read_b128 v[56:59], v182 offset:0
v_mfma_f32_32x32x16_bf16 v[16:31], v[104:107], v[72:75], v[16:31]
ds_read_b64_tr_b16 v[100:101], v184 offset:22528
ds_read_b64_tr_b16 v[102:103], v184 offset:23040
ds_read_b128 v[68:71], v181 offset:2048
buffer_load_dwordx4 v177, s[44:47], 0 offen offset:3072 lds
ds_read_b64_tr_b16 v[92:93], v184 offset:28672
ds_read_b64_tr_b16 v[94:95], v184 offset:29184
ds_read_b128 v[60:63], v183 offset:0
v_mfma_f32_32x32x16_bf16 v[16:31], v[108:111], v[76:79], v[16:31]
ds_read_b64_tr_b16 v[104:105], v184 offset:26624
ds_read_b64_tr_b16 v[106:107], v184 offset:27136
ds_read_b128 v[72:75], v182 offset:2048
ds_read_b64_tr_b16 v[108:109], v184 offset:30720
ds_read_b64_tr_b16 v[110:111], v184 offset:31232
ds_read_b128 v[76:79], v183 offset:2048
s_waitcnt lgkmcnt(15)
v_mfma_f32_32x32x16_bf16 v[16:31], v[80:83], v[48:51], v[16:31]
s_add_u32 m0, s39, 81920
s_mov_b32 s10, 720896
buffer_load_dwordx4 v2, s[48:51], s10 offen lds
s_waitcnt lgkmcnt(15)
v_mfma_f32_32x32x16_bf16 v[16:31], v[84:87], v[52:55], v[16:31]
buffer_load_dwordx4 v3, s[48:51], s10 offen offset:1024 lds
v_lshl_add_u32 v152, v152, 7, v4
v_lshl_add_u32 v178, v178, 7, v5
v_lshl_add_u32 v153, v153, 7, v6
v_lshl_add_u32 v179, v179, 7, v7
s_waitcnt lgkmcnt(12)
v_mfma_f32_32x32x16_bf16 v[16:31], v[88:91], v[56:59], v[16:31]
s_mov_b32 s10, 751616
buffer_load_dwordx4 v2, s[48:51], s10 offen offset:2048 lds
s_waitcnt lgkmcnt(6)
v_mfma_f32_32x32x16_bf16 v[16:31], v[92:95], v[60:63], v[16:31]
buffer_load_dwordx4 v3, s[48:51], s10 offen offset:3072 lds
s_add_u32 m0, s39, 0
s_waitcnt vmcnt(11) lgkmcnt(0)
s_barrier
buffer_load_dwordx4 v152, s[44:47], 0 offen lds
ds_read_b64_tr_b16 v[80:81], v184 offset:49152
ds_read_b64_tr_b16 v[82:83], v184 offset:49664
ds_read_b128 v[48:51], v180 offset:32768
v_mfma_f32_32x32x16_bf16 v[16:31], v[96:99], v[64:67], v[16:31]
buffer_load_dwordx4 v178, s[44:47], 0 offen offset:1024 lds
ds_read_b64_tr_b16 v[84:85], v184 offset:53248
ds_read_b64_tr_b16 v[86:87], v184 offset:53760
ds_read_b128 v[52:55], v181 offset:32768
v_mfma_f32_32x32x16_bf16 v[16:31], v[100:103], v[68:71], v[16:31]
ds_read_b64_tr_b16 v[96:97], v184 offset:51200
ds_read_b64_tr_b16 v[98:99], v184 offset:51712
ds_read_b128 v[64:67], v180 offset:34816
buffer_load_dwordx4 v153, s[44:47], 0 offen offset:2048 lds
ds_read_b64_tr_b16 v[88:89], v184 offset:57344
ds_read_b64_tr_b16 v[90:91], v184 offset:57856
ds_read_b128 v[56:59], v182 offset:32768
v_mfma_f32_32x32x16_bf16 v[16:31], v[104:107], v[72:75], v[16:31]
ds_read_b64_tr_b16 v[100:101], v184 offset:55296
ds_read_b64_tr_b16 v[102:103], v184 offset:55808
ds_read_b128 v[68:71], v181 offset:34816
buffer_load_dwordx4 v179, s[44:47], 0 offen offset:3072 lds
ds_read_b64_tr_b16 v[92:93], v184 offset:61440
ds_read_b64_tr_b16 v[94:95], v184 offset:61952
ds_read_b128 v[60:63], v183 offset:32768
v_mfma_f32_32x32x16_bf16 v[16:31], v[108:111], v[76:79], v[16:31]
TS_14:
s_cbranch_execz RET_a
ds_read_b64_tr_b16 v[104:105], v184 offset:59392
ds_read_b64_tr_b16 v[106:107], v184 offset:59904
ds_read_b128 v[72:75], v182 offset:34816
ds_read_b64_tr_b16 v[108:109], v184 offset:63488
ds_read_b64_tr_b16 v[110:111], v184 offset:64000
ds_read_b128 v[76:79], v183 offset:34816
s_waitcnt lgkmcnt(15)
v_mfma_f32_32x32x16_bf16 v[16:31], v[80:83], v[48:51], v[16:31]
s_add_u32 m0, s39, 16384
s_mov_b32 s10, 786432
buffer_load_dwordx4 v2, s[48:51], s10 offen lds
s_waitcnt lgkmcnt(15)
v_mfma_f32_32x32x16_bf16 v[16:31], v[84:87], v[52:55], v[16:31]
buffer_load_dwordx4 v3, s[48:51], s10 offen offset:1024 lds
s_waitcnt lgkmcnt(12)
v_mfma_f32_32x32x16_bf16 v[16:31], v[88:91], v[56:59], v[16:31]
s_mov_b32 s10, 817152
buffer_load_dwordx4 v2, s[48:51], s10 offen offset:2048 lds
s_waitcnt lgkmcnt(6)
v_mfma_f32_32x32x16_bf16 v[16:31], v[92:95], v[60:63], v[16:31]
buffer_load_dwordx4 v3, s[48:51], s10 offen offset:3072 lds
s_waitcnt vmcnt(8) lgkmcnt(0)
s_barrier
D_fchk:
v_cmp_ne_u64 vcc, v[206:207], v[208:209]
v_cmp_ne_u64 s[4:5], v[206:207], v[210:211]
v_cmp_eq_u32 s[6:7], 0, v206
s_or_b64 s[4:5], s[4:5], vcc
s_or_b64 s[4:5], s[4:5], s[6:7]
s_cbranch_scc1 D_fslow
D_fok:
s_add_u32 m0, s54, 0
s_add_u32 s4, s55, 0
buffer_load_dwordx4 v1, s[60:63], s4 offen sc1 lds
ds_read_b64_tr_b16 v[80:81], v189 offset:16384
ds_read_b64_tr_b16 v[82:83], v189 offset:16896
ds_read_b128 v[48:51], v185 offset:0
v_mfma_f32_32x32x16_bf16 v[16:31], v[96:99], v[64:67], v[16:31]
s_add_u32 m0, s54, 4096
s_add_u32 s4, s55, 4096
buffer_load_dwordx4 v1, s[60:63], s4 offen sc1 lds
ds_read_b64_tr_b16 v[84:85], v189 offset:20480
ds_read_b64_tr_b16 v[86:87], v189 offset:20992
ds_read_b128 v[52:55], v186 offset:0
v_mfma_f32_32x32x16_bf16 v[16:31], v[100:103], v[68:71], v[16:31]
ds_read_b64_tr_b16 v[96:97], v189 offset:18432
ds_read_b64_tr_b16 v[98:99], v189 offset:18944
ds_read_b128 v[64:67], v185 offset:2048
s_add_u32 m0, s54, 8192
s_add_u32 s4, s55, 8192
buffer_load_dwordx4 v1, s[60:63], s4 offen sc1 lds
ds_read_b64_tr_b16 v[88:89], v189 offset:24576
ds_read_b64_tr_b16 v[90:91], v189 offset:25088
ds_read_b128 v[56:59], v187 offset:0
v_mfma_f32_32x32x16_bf16 v[16:31], v[104:107], v[72:75], v[16:31]
ds_read_b64_tr_b16 v[100:101], v189 offset:22528
ds_read_b64_tr_b16 v[102:103], v189 offset:23040
ds_read_b128 v[68:71], v186 offset:2048
s_add_u32 m0, s54, 12288
s_add_u32 s4, s55, 12288
buffer_load_dwordx4 v1, s[60:63], s4 offen sc1 lds
ds_read_b64_tr_b16 v[92:93], v189 offset:28672
ds_read_b64_tr_b16 v[94:95], v189 offset:29184
ds_read_b128 v[60:63], v188 offset:0
v_mfma_f32_32x32x16_bf16 v[16:31], v[108:111], v[76:79], v[16:31]
ds_read_b64_tr_b16 v[104:105], v189 offset:26624
ds_read_b64_tr_b16 v[106:107], v189 offset:27136
ds_read_b128 v[72:75], v187 offset:2048
ds_read_b64_tr_b16 v[108:109], v189 offset:30720
ds_read_b64_tr_b16 v[110:111], v189 offset:31232
ds_read_b128 v[76:79], v188 offset:2048
s_waitcnt lgkmcnt(15)
v_mfma_f32_32x32x16_bf16 v[16:31], v[80:83], v[48:51], v[16:31]
s_add_u32 m0, s54, 16384
s_add_u32 s4, s55, 16384
buffer_load_dwordx4 v1, s[60:63], s4 offen sc1 lds
s_waitcnt lgkmcnt(15)
v_mfma_f32_32x32x16_bf16 v[16:31], v[84:87], v[52:55], v[16:31]
s_add_u32 m0, s54, 20480
s_add_u32 s4, s55, 20480
buffer_load_dwordx4 v1, s[60:63], s4 offen sc1 lds
s_waitcnt lgkmcnt(12)
v_mfma_f32_32x32x16_bf16 v[16:31], v[88:91], v[56:59], v[16:31]
s_add_u32 m0, s54, 24576
s_add_u32 s4, s55, 24576
buffer_load_dwordx4 v1, s[60:63], s4 offen sc1 lds
s_waitcnt lgkmcnt(6)
v_mfma_f32_32x32x16_bf16 v[16:31], v[92:95], v[60:63], v[16:31]
s_add_u32 m0, s54, 28672
s_add_u32 s4, s55, 28672
buffer_load_dwordx4 v1, s[60:63], s4 offen sc1 lds
s_waitcnt vmcnt(8) lgkmcnt(0)
s_barrier
s_add_u32 m0, s54, 32768
s_add_u32 s4, s55, 32768
buffer_load_dwordx4 v1, s[60:63], s4 offen sc1 lds
ds_read_b64_tr_b16 v[80:81], v184 offset:16384
ds_read_b64_tr_b16 v[82:83], v184 offset:16896
ds_read_b128 v[48:51], v180 offset:0
v_mfma_f32_32x32x16_bf16 v[16:31], v[96:99], v[64:67], v[16:31]
s_add_u32 m0, s54, 36864
s_add_u32 s4, s55, 36864
buffer_load_dwordx4 v1, s[60:63], s4 offen sc1 lds
ds_read_b64_tr_b16 v[84:85], v184 offset:20480
ds_read_b64_tr_b16 v[86:87], v184 offset:20992
ds_read_b128 v[52:55], v181 offset:0
v_mfma_f32_32x32x16_bf16 v[16:31], v[100:103], v[68:71], v[16:31]
ds_read_b64_tr_b16 v[96:97], v184 offset:18432
ds_read_b64_tr_b16 v[98:99], v184 offset:18944
ds_read_b128 v[64:67], v180 offset:2048
s_add_u32 m0, s54, 40960
s_add_u32 s4, s55, 40960
buffer_load_dwordx4 v1, s[60:63], s4 offen sc1 lds
ds_read_b64_tr_b16 v[88:89], v184 offset:24576
ds_read_b64_tr_b16 v[90:91], v184 offset:25088
ds_read_b128 v[56:59], v182 offset:0
v_mfma_f32_32x32x16_bf16 v[16:31], v[104:107], v[72:75], v[16:31]
ds_read_b64_tr_b16 v[100:101], v184 offset:22528
ds_read_b64_tr_b16 v[102:103], v184 offset:23040
ds_read_b128 v[68:71], v181 offset:2048
s_add_u32 m0, s54, 45056
s_add_u32 s4, s55, 45056
buffer_load_dwordx4 v1, s[60:63], s4 offen sc1 lds
ds_read_b64_tr_b16 v[92:93], v184 offset:28672
ds_read_b64_tr_b16 v[94:95], v184 offset:29184
ds_read_b128 v[60:63], v183 offset:0
v_mfma_f32_32x32x16_bf16 v[16:31], v[108:111], v[76:79], v[16:31]
ds_read_b64_tr_b16 v[104:105], v184 offset:26624
ds_read_b64_tr_b16 v[106:107], v184 offset:27136
ds_read_b128 v[72:75], v182 offset:2048
ds_read_b64_tr_b16 v[108:109], v184 offset:30720
ds_read_b64_tr_b16 v[110:111], v184 offset:31232
ds_read_b128 v[76:79], v183 offset:2048
s_waitcnt lgkmcnt(15)
v_mfma_f32_32x32x16_bf16 v[16:31], v[80:83], v[48:51], v[16:31]
s_add_u32 m0, s54, 49152
s_add_u32 s4, s55, 49152
buffer_load_dwordx4 v1, s[60:63], s4 offen sc1 lds
s_waitcnt lgkmcnt(15)
s_nop 0
v_mfma_f32_32x32x16_bf16 v[16:31], v[84:87], v[52:55], v[16:31]
s_waitcnt lgkmcnt(12)
v_mfma_f32_32x32x16_bf16 v[16:31], v[88:91], v[56:59], v[16:31]
s_waitcnt lgkmcnt(6)
v_mfma_f32_32x32x16_bf16 v[16:31], v[92:95], v[60:63], v[16:31]
s_waitcnt lgkmcnt(9)
v_mfma_f32_32x32x16_bf16 v[16:31], v[96:99], v[64:67], v[16:31]
s_waitcnt vmcnt(5)
s_barrier
s_waitcnt lgkmcnt(6)
v_mfma_f32_32x32x16_bf16 v[16:31], v[100:103], v[68:71], v[16:31]
s_waitcnt lgkmcnt(3)
v_mfma_f32_32x32x16_bf16 v[16:31], v[104:107], v[72:75], v[16:31]
s_waitcnt lgkmcnt(0)
v_mfma_f32_32x32x16_bf16 v[16:31], v[108:111], v[76:79], v[16:31]
s_setprio 0
s_nop 10
v_mul_f32 v32, v16, v16
v_mul_f32 v33, v17, v17
v_mul_f32 v34, v18, v18
v_mul_f32 v35, v19, v19
v_mul_f32 v36, v20, v20
v_mul_f32 v37, v21, v21
v_mul_f32 v38, v22, v22
v_mul_f32 v39, v23, v23
v_mul_f32 v40, v24, v24
v_mul_f32 v41, v25, v25
v_mul_f32 v42, v26, v26
v_mul_f32 v43, v27, v27
v_mul_f32 v44, v28, v28
v_mul_f32 v45, v29, v29
v_mul_f32 v46, v30, v30
v_mul_f32 v47, v31, v31
v_fma_f32 v32, v32, s73, v8
v_fma_f32 v33, v33, s73, v8
v_fma_f32 v34, v34, s73, v8
v_fma_f32 v35, v35, s73, v8
v_fma_f32 v36, v36, s73, v8
v_fma_f32 v37, v37, s73, v8
v_fma_f32 v38, v38, s73, v8
v_fma_f32 v39, v39, s73, v8
v_fma_f32 v40, v40, s73, v8
v_fma_f32 v41, v41, s73, v8
v_fma_f32 v42, v42, s73, v8
v_fma_f32 v43, v43, s73, v8
v_fma_f32 v44, v44, s73, v8
v_fma_f32 v45, v45, s73, v8
v_fma_f32 v46, v46, s73, v8
v_fma_f32 v47, v47, s73, v8
v_mul_f32 v32, v32, v16
v_mul_f32 v33, v33, v17
v_mul_f32 v34, v34, v18
v_mul_f32 v35, v35, v19
v_mul_f32 v36, v36, v20
v_mul_f32 v37, v37, v21
v_mul_f32 v38, v38, v22
v_mul_f32 v39, v39, v23
v_mul_f32 v40, v40, v24
v_mul_f32 v41, v41, v25
v_mul_f32 v42, v42, v26
v_mul_f32 v43, v43, v27
v_mul_f32 v44, v44, v28
v_mul_f32 v45, v45, v29
v_mul_f32 v46, v46, v30
v_mul_f32 v47, v47, v31
s_waitcnt vmcnt(0)
s_barrier
v_exp_f32 v32, v32
v_exp_f32 v33, v33
v_exp_f32 v34, v34
v_exp_f32 v35, v35
v_exp_f32 v36, v36
v_exp_f32 v37, v37
v_exp_f32 v38, v38
v_exp_f32 v39, v39
v_exp_f32 v40, v40
v_exp_f32 v41, v41
v_exp_f32 v42, v42
v_exp_f32 v43, v43
v_exp_f32 v44, v44
v_exp_f32 v45, v45
v_exp_f32 v46, v46
v_exp_f32 v47, v47
v_add_f32 v32, 1.0, v32
v_add_f32 v33, 1.0, v33
v_add_f32 v34, 1.0, v34
v_add_f32 v35, 1.0, v35
v_add_f32 v36, 1.0, v36
v_add_f32 v37, 1.0, v37
v_add_f32 v38, 1.0, v38
v_add_f32 v39, 1.0, v39
v_add_f32 v40, 1.0, v40
v_add_f32 v41, 1.0, v41
v_add_f32 v42, 1.0, v42
v_add_f32 v43, 1.0, v43
v_add_f32 v44, 1.0, v44
v_add_f32 v45, 1.0, v45
v_add_f32 v46, 1.0, v46
v_add_f32 v47, 1.0, v47
v_rcp_f32 v32, v32
v_rcp_f32 v33, v33
v_rcp_f32 v34, v34
v_rcp_f32 v35, v35
v_rcp_f32 v36, v36
v_rcp_f32 v37, v37
v_rcp_f32 v38, v38
v_rcp_f32 v39, v39
v_rcp_f32 v40, v40
v_rcp_f32 v41, v41
v_rcp_f32 v42, v42
v_rcp_f32 v43, v43
v_rcp_f32 v44, v44
v_rcp_f32 v45, v45
v_rcp_f32 v46, v46
v_rcp_f32 v47, v47
v_mul_f32 v16, v16, v32
v_mul_f32 v17, v17, v33
v_mul_f32 v18, v18, v34
v_mul_f32 v19, v19, v35
v_mul_f32 v20, v20, v36
v_mul_f32 v21, v21, v37
v_mul_f32 v22, v22, v38
v_mul_f32 v23, v23, v39
v_mul_f32 v24, v24, v40
v_mul_f32 v25, v25, v41
v_mul_f32 v26, v26, v42
v_mul_f32 v27, v27, v43
v_mul_f32 v28, v28, v44
v_mul_f32 v29, v29, v45
v_mul_f32 v30, v30, v46
v_mul_f32 v31, v31, v47
v_cvt_pk_bf16_f32 v32, v16, v17
v_cvt_pk_bf16_f32 v33, v18, v19
v_cvt_pk_bf16_f32 v34, v20, v21
v_cvt_pk_bf16_f32 v35, v22, v23
v_cvt_pk_bf16_f32 v36, v24, v25
v_cvt_pk_bf16_f32 v37, v26, v27
v_cvt_pk_bf16_f32 v38, v28, v29
v_cvt_pk_bf16_f32 v39, v30, v31
v_mfma_f32_32x32x16_bf16 v[48:63], v[240:243], v[32:35], 0
s_nop 0
v_mfma_f32_32x32x16_bf16 v[48:63], v[244:247], v[36:39], v[48:63]
s_mov_b64 exec, s[76:77]
s_nop 10
ds_write_b32 v205, v48
s_waitcnt lgkmcnt(0)
s_barrier
L_exit:
s_endpgm
.section .rodata,"a"
.p2align 6
.amdhsa_kernel standalone__deep_cross_fibinet__recsys_kernel
  .amdhsa_next_free_vgpr 256
  .amdhsa_next_free_sgpr 102
  .amdhsa_accum_offset 256
  .amdhsa_group_segment_fixed_size 0
  .amdhsa_kernarg_size 88
  .amdhsa_user_sgpr_count 2
  .amdhsa_user_sgpr_kernarg_segment_ptr 1
  .amdhsa_system_sgpr_workgroup_id_x 1
.end_amdhsa_kernel
```
